```python
import torch

def _softmax(x, axis=-1):
    return torch.softmax(x, dim=axis)
def _gelu(x):
    return torch.nn.functional.gelu(x, approximate="tanh")
def _silu(x):
    return torch.nn.functional.silu(x)
def _sigmoid(x):
    return torch.sigmoid(x)
def _layernorm(x, axis=-1, eps=1e-5):
    m = x.mean(dim=axis, keepdim=True)
    v = x.var(dim=axis, keepdim=True, unbiased=False)
    return (x - m) / torch.sqrt(v + eps)
def _scatter_add(tgt, idx, src, axis=0):
    return tgt.clone().index_add_(axis, idx, src)
def _segment_sum(src, seg, n):
    out = torch.zeros((n,) + src.shape[1:], dtype=src.dtype)
    return out.index_add_(0, seg, src)
def _pad(x, pw):
    flat = tuple(v for pair in reversed(pw) for v in pair)
    return torch.nn.functional.pad(x, flat)

kernel_name = 'gated_mix__mha_block_cached__dense_activation_relu__decode'

def setup_inputs():

    _w = (lambda a: (lambda t: t.to(torch.bfloat16) if t.is_floating_point() else t)(torch.as_tensor(a)))
    def _A_setup():
        B, Sq, D = 2, 1, 448
        H, Sk, Dh = 16, 4096, 256
        return {
            "x": _w((lambda *s: torch.randn(*s, dtype=torch.bfloat16) * 0.05)(B, Sq, D)),
            "k_cache": _w((lambda *s: torch.randn(*s, dtype=torch.bfloat16) * 6.4)(B, H, Sk, Dh)),
            "v_cache": _w((lambda *s: torch.randn(*s, dtype=torch.bfloat16) * 0.4)(B, H, Sk, Dh)),
            "wq": _w((lambda *s: torch.randn(*s, dtype=torch.bfloat16) * 6.4)(D, H * Dh) * (D ** -0.5)),
            "wo": _w((lambda *s: torch.randn(*s, dtype=torch.bfloat16) * 0.4)(H * Dh, D) * ((H * Dh) ** -0.5)),
        }
    _A_in = _A_setup()

    def _B_setup():
        B, S, D, Dff = 2, 1, 448, 1792
        return {
            "x": _w((lambda *s: torch.randn(*s, dtype=torch.bfloat16) * 0.05)(B, S, D)),
            "w1": _w((lambda *s: torch.randn(*s, dtype=torch.bfloat16) * 0.05)(D, Dff)),
            "w2": _w((lambda *s: torch.randn(*s, dtype=torch.bfloat16) * 0.05)(Dff, D)),
        }
    _B_in = _B_setup()

    return {
        "A_x": _A_in["x"],
        "A_k_cache": _A_in["k_cache"],
        "A_v_cache": _A_in["v_cache"],
        "A_wq": _A_in["wq"],
        "A_wo": _A_in["wo"],
        "B_x": _B_in["x"],
        "B_w1": _B_in["w1"],
        "B_w2": _B_in["w2"],
        "gate_w": _w((lambda *s: torch.randn(*s, dtype=torch.bfloat16) * 0.05)(448) * 16.0),
    }

def reference(A_x, A_k_cache, A_v_cache, A_wq, A_wo, B_x, B_w1, B_w2, gate_w):
    def _A_ref(x, k_cache, v_cache, wq, wo):
        B, Sq, D = x.shape
        H, Dh = 16, 256
        q = (lambda x, *d: x.permute(*d))((x @ wq).reshape(B, Sq, H, Dh), 0, 2, 1, 3)
        scores = torch.einsum("bhqd,bhkd->bhqk", q, k_cache) * (Dh ** -0.5)
        p = _softmax(scores, axis=-1)
        o = torch.einsum("bhqk,bhkd->bhqd", p, v_cache)
        return (lambda x, *d: x.permute(*d))(o, 0, 2, 1, 3).reshape(B, Sq, H * Dh) @ wo

    def _B_ref(x, w1, w2):
        h = torch.einsum("bsd,df->bsf", x, w1)
        zero = torch.zeros_like(h)
        h = torch.maximum(h, zero)
        return torch.einsum("bsf,fd->bsd", h, w2)

    x = A_x
    g = _sigmoid((x * gate_w).sum(-1, keepdims=True))
    a = _A_ref(x, A_k_cache, A_v_cache, A_wq, A_wo)
    b = _B_ref(x, B_w1, B_w2)
    return g * a + (1 - g) * b
```

```asm
; @launch grid=(256,1,1) block=(576,1,1) lds=163840
.amdgcn_target "amdgcn-amd-amdhsa--gfx950"
.text
.globl gated_mix__mha_block_cached__dense_activation_relu__decode_kernel
.p2align 8
.type gated_mix__mha_block_cached__dense_activation_relu__decode_kernel,@function
gated_mix__mha_block_cached__dense_activation_relu__decode_kernel:
    s_load_dwordx4 s[36:39], s[0:1], 8
    v_readfirstlane_b32 s75, v0
    s_cmpk_ge_u32 s2, 256
    s_cbranch_scc1 L_end
    s_lshr_b32 s75, s75, 6
    s_cbranch_scc0 L_loader
    s_getpc_b64 s[100:101]
    s_lshr_b32 s3, s2, 3
    s_mulk_i32 s3, 640
    v_subrev_u32 v28, 64, v0
    v_cmp_gt_u32 vcc, 5, v28
    v_lshl_add_u32 v28, v28, 7, s3
    s_and_saveexec_b64 s[98:99], vcc
    s_cbranch_execz L_cons0
    global_load_dword v24, v28, s[100:101]
    s_branch L_cons0
L_loader:
    s_and_b32 s72, s2, 7
    s_lshl_b32 s72, s72, 1
    s_bfe_u32 s76, s2, 0x10003
    s_add_u32 s72, s72, s76
    s_bfe_u32 s73, s2, 0x10004
    s_lshr_b32 s74, s2, 5
    s_lshl_b32 s76, s73, 4
    s_add_u32 s76, s76, s72
    s_lshl3_add_u32 s76, s76, s74
    s_lshl_b32 s76, s76, 18
    v_lshl_add_u32 v2, v0, 4, s76
    s_lshl_b32 s30, 1, 26
    s_mov_b32 s31, 0x20000
    s_lshl_b32 m0, 1, 15
    s_mov_b32 s34, 0
    s_waitcnt lgkmcnt(0)
    s_mov_b64 s[28:29], s[36:37]
L_burst:
    buffer_load_dwordx4 v2, s[28:31], s34 offen offset:0 nt lds
    buffer_load_dwordx4 v2, s[28:31], s34 offen offset:1024 nt lds
    buffer_load_dwordx4 v2, s[28:31], s34 offen offset:2048 nt lds
    buffer_load_dwordx4 v2, s[28:31], s34 offen offset:3072 nt lds
    s_addk_i32 s34, 4096
    s_addk_i32 m0, 4096
    s_cmpk_lt_u32 s34, 32768
    s_cbranch_scc1 L_burst
    s_setprio 3
    v_mov_b32 v1, v0
    s_mov_b32 s83, 1000000
    v_lshlrev_b32 v4, 2, v1
    v_mov_b32 v5, 0
    ds_write_b32 v4, v5 offset:25856
    ds_write_b32 v4, v5 offset:25600
    ds_write_b32 v4, v5 offset:0
    v_and_b32 v6, 7, v1
    v_lshlrev_b32 v6, 2, v6
    s_mov_b32 s32, 4
    s_mov_b32 s33, 16
    s_waitcnt lgkmcnt(0)
    s_barrier
    s_branch L_ldok0
L_cons0:
    s_mov_b64 exec, -1
    s_load_dwordx16 s[4:19], s[0:1], 0
    s_load_dwordx8 s[20:27], s[0:1], 64
    s_and_b32 s72, s2, 7
    s_lshl_b32 s72, s72, 1
    s_bfe_u32 s76, s2, 0x10003
    s_add_u32 s72, s72, s76
    s_bfe_u32 s73, s2, 0x10004
    s_lshr_b32 s74, s2, 5
    v_and_b32 v1, 63, v0
    s_mov_b32 s83, 1000000
    s_sub_u32 s75, s75, 1
    s_mov_b32 s71, 0
    s_lshl_b32 s76, s75, 10
    s_add_u32 s76, s76, 32768
    v_lshl_add_u32 v2, v1, 4, s76
    v_add_u32 v0, 0x10000, v2
    s_lshl_b32 s76, s75, 2
    v_mov_b32 v27, s76
    v_mov_b32 v26, s76
    s_barrier
    s_branch L_cons
L_ld0:
    s_cmp_lt_u32 s32, s33
    s_cbranch_scc1 L_ldok0
L_ldfree0:
    ds_read_b32 v7, v6 offset:25600
    s_waitcnt lgkmcnt(0)
    v_min_u32_dpp v7, v7, v7 quad_perm:[1,0,3,2] row_mask:0xf bank_mask:0xf
    s_nop 1
    v_min_u32_dpp v7, v7, v7 quad_perm:[2,3,0,1] row_mask:0xf bank_mask:0xf
    s_nop 1
    v_min_u32_dpp v7, v7, v7 row_half_mirror row_mask:0xf bank_mask:0xf
    s_nop 0
    v_readfirstlane_b32 s33, v7
    s_nop 0
    s_add_u32 s33, s33, 16
    s_cmp_lt_u32 s32, s33
    s_cbranch_scc1 L_ldok0
    s_cmp_eq_u32 s83, 0
    s_cbranch_scc1 L_ldok0
    s_sub_u32 s83, s83, 1
    s_branch L_ldfree0
L_ldok0:
    s_and_b32 s35, s32, 15
    s_lshl_b32 s35, s35, 13
    s_add_u32 s35, s35, 32768
    s_mov_b32 m0, s35
    s_sub_u32 s40, s32, 3
    v_mov_b32 v5, s40
    s_waitcnt vmcnt(31)
    buffer_load_dwordx4 v2, s[28:31], s34 offen offset:0 nt lds
    s_waitcnt vmcnt(31)
    buffer_load_dwordx4 v2, s[28:31], s34 offen offset:1024 nt lds
    s_waitcnt vmcnt(31)
    buffer_load_dwordx4 v2, s[28:31], s34 offen offset:2048 nt lds
    s_waitcnt vmcnt(31)
    buffer_load_dwordx4 v2, s[28:31], s34 offen offset:3072 nt lds
    s_add_u32 s35, s35, 4096
    s_add_u32 s34, s34, 4096
    s_mov_b32 m0, s35
    s_waitcnt vmcnt(31)
    buffer_load_dwordx4 v2, s[28:31], s34 offen offset:0 nt lds
    s_waitcnt vmcnt(31)
    buffer_load_dwordx4 v2, s[28:31], s34 offen offset:1024 nt lds
    s_waitcnt vmcnt(31)
    buffer_load_dwordx4 v2, s[28:31], s34 offen offset:2048 nt lds
    s_waitcnt vmcnt(31)
    ds_write_b32 v4, v5 offset:25856
    buffer_load_dwordx4 v2, s[28:31], s34 offen offset:3072 nt lds
    s_add_u32 s34, s34, 4096
    s_add_u32 s32, s32, 1
    s_cmp_lg_u32 s32, 32
    s_cbranch_scc1 L_ldnsw0
    s_mov_b32 s28, s38
    s_mov_b32 s29, s39
    s_mov_b32 s34, 0
L_ldnsw0:
    s_cmp_lt_u32 s32, 63
    s_cbranch_scc1 L_ld0
    s_load_dwordx8 s[20:27], s[0:1], 64
    s_waitcnt lgkmcnt(0)
    s_lshl_b32 s3, s73, 7
    s_add_u32 s3, s3, 4194304
    s_load_dwordx2 s[68:69], s[26:27], s3
    s_mov_b32 s64, s26
    s_mov_b32 s65, s27
    s_mov_b32 s66, 4194560
    s_mov_b32 s67, 0x20000
    s_mov_b32 s60, s22
    s_mov_b32 s61, s23
    s_mov_b32 s62, 1792
    s_mov_b32 s63, 0x20000
    v_mov_b32 v5, 60
    s_waitcnt vmcnt(24)
    ds_write_b32 v4, v5 offset:25856
    v_mov_b32 v5, 61
    s_waitcnt vmcnt(16)
    ds_write_b32 v4, v5 offset:25856
    v_mov_b32 v5, 62
    s_waitcnt vmcnt(8)
    ds_write_b32 v4, v5 offset:25856
    v_mov_b32 v5, 63
    s_waitcnt vmcnt(0)
    ds_write_b32 v4, v5 offset:25856
    s_waitcnt lgkmcnt(0)
    s_add_u32 s68, s68, 8
    s_add_u32 s69, s69, 1
    s_branch L_lsvc
L_cons:
    s_waitcnt lgkmcnt(0)
    s_lshl_b32 s3, s73, 7
    s_add_u32 s3, s3, 4194304
    s_load_dwordx2 s[68:69], s[26:27], s3
    s_cmp_eq_u32 s75, 7
    s_cbranch_scc1 L_svc
    s_mov_b32 s36, s10
    s_mov_b32 s37, s11
    s_mov_b32 s38, 3670016
    s_mov_b32 s39, 0x20000
    s_mul_i32 s76, s74, 56
    s_lshl_b32 s77, s75, 3
    s_add_u32 s76, s76, s77
    v_lshrrev_b32 v28, 5, v1
    v_add_u32 v29, s76, v28
    v_lshlrev_b32 v5, 13, v29
    v_and_b32 v30, 31, v1
    v_lshl_add_u32 v5, v30, 4, v5
    s_lshl_b32 s77, s72, 9
    v_add_u32 v5, s77, v5
    buffer_load_dwordx4 v[104:107], v5, s[36:39], 0 offen nt
    s_mov_b32 s77, 16384
    buffer_load_dwordx4 v[108:111], v5, s[36:39], s77 offen nt
    s_mov_b32 s77, 32768
    buffer_load_dwordx4 v[112:115], v5, s[36:39], s77 offen nt
    s_mov_b32 s77, 49152
    buffer_load_dwordx4 v[116:119], v5, s[36:39], s77 offen nt
    s_mov_b32 s52, s4
    s_mov_b32 s53, s5
    s_mov_b32 s54, 1792
    s_mov_b32 s55, 0x20000
    s_mov_b32 s40, s16
    s_mov_b32 s41, s17
    s_mov_b32 s42, 1605632
    s_mov_b32 s43, 0x20000
    v_lshrrev_b32 v31, 4, v1
    v_and_b32 v32, 15, v1
    v_add_u32 v33, s76, v31
    v_mul_u32_u24 v6, 3584, v33
    v_lshl_add_u32 v6, v32, 4, v6
    s_lshl_b32 s77, s72, 8
    v_add_u32 v6, s77, v6
    s_cmp_gt_u32 s72, 13
    s_cbranch_scc1 L_nof1
    s_mov_b32 s77, 14336
    buffer_load_dwordx4 v[120:123], v6, s[40:43], 0 offen nt
    buffer_load_dwordx4 v[124:127], v6, s[40:43], s77 offen nt
L_nof1:
    s_mul_i32 s77, s73, 448
    s_add_u32 s77, s77, s76
    v_and_b32 v33, 3, v1
    v_lshl_add_u32 v33, v33, 1, v28
    v_add_lshl_u32 v3, v33, s77, 1
    v_and_b32 v33, 1, v1
    v_lshl_add_u32 v33, v33, 2, v31
    v_add_lshl_u32 v4, v33, s77, 1
    buffer_load_ushort v128, v3, s[52:55], 0 offen
    buffer_load_ushort v130, v4, s[52:55], 0 offen
    s_mov_b32 s64, s26
    s_mov_b32 s65, s27
    s_mov_b32 s66, 4194560
    s_mov_b32 s67, 0x20000
    s_mov_b32 s44, s12
    s_mov_b32 s45, s13
    s_mov_b32 s46, 3670016
    s_mov_b32 s47, 0x20000
    s_mov_b32 s48, s18
    s_mov_b32 s49, s19
    s_mov_b32 s50, 1605632
    s_mov_b32 s51, 0x20000
    s_mov_b32 s60, s22
    s_mov_b32 s61, s23
    s_mov_b32 s62, 1792
    s_mov_b32 s63, 0x20000
    s_mov_b32 s56, s20
    s_mov_b32 s57, s21
    s_mov_b32 s58, 896
    s_mov_b32 s59, 0x20000
    s_mov_b32 s32, s8
    s_mov_b32 s33, s9
    s_mov_b32 s34, 67108864
    s_mov_b32 s35, 0x20000
    v_mov_b32 v136, 0
    v_mov_b32 v137, 0
    v_mov_b32 v138, 0
    v_mov_b32 v139, 0
    v_mov_b32 v140, 0
    v_mov_b32 v141, 0
    v_mov_b32 v142, 0
    v_mov_b32 v143, 0
    v_mov_b32 v144, 0
    v_mov_b32 v145, 0
    v_mov_b32 v146, 0
    v_mov_b32 v147, 0
    v_mov_b32 v148, 0
    v_mov_b32 v149, 0
    v_mov_b32 v150, 0
    v_mov_b32 v151, 0
    s_mul_i32 s76, s75, 1536
    v_lshlrev_b32 v30, 5, v30
    v_lshl_add_u32 v30, v28, 4, v30
    v_add_u32 v30, s76, v30
    v_lshlrev_b32 v32, 5, v32
    v_lshl_add_u32 v32, v31, 3, v32
    v_add_u32 v32, s76, v32
    s_cmp_gt_u32 s71, 0
    s_cbranch_scc1 L_ck_1
L_cs_2:
    ds_read_b32 v39, v26 offset:25856
    s_waitcnt lgkmcnt(0)
    v_readfirstlane_b32 s71, v39
    s_nop 0
    s_cmp_gt_u32 s71, 0
    s_cbranch_scc1 L_ck_1
    s_cmp_eq_u32 s83, 0
    s_cbranch_scc1 L_ck_1
    s_sub_u32 s83, s83, 1
    s_sleep 1
    s_branch L_cs_2
L_ck_1:
    ds_read_b128 v[40:43], v2 offset:0
    s_cmp_gt_u32 s71, 1
    s_cbranch_scc1 L_ck_3
L_cs_4:
    ds_read_b32 v39, v26 offset:25856
    s_waitcnt lgkmcnt(0)
    v_readfirstlane_b32 s71, v39
    s_nop 0
    s_cmp_gt_u32 s71, 1
    s_cbranch_scc1 L_ck_3
    s_cmp_eq_u32 s83, 0
    s_cbranch_scc1 L_ck_3
    s_sub_u32 s83, s83, 1
    s_sleep 1
    s_branch L_cs_4
L_ck_3:
    ds_read_b128 v[44:47], v2 offset:8192
    v_mov_b32 v38, 2
    s_waitcnt lgkmcnt(0)
    s_mov_b64 exec, 1
    ds_write_b32 v27, v38 offset:25600
    s_mov_b64 exec, -1
    s_cmp_gt_u32 s71, 2
    s_cbranch_scc1 L_ck_5
L_cs_6:
    ds_read_b32 v39, v26 offset:25856
    s_waitcnt lgkmcnt(0)
    v_readfirstlane_b32 s71, v39
    s_nop 0
    s_cmp_gt_u32 s71, 2
    s_cbranch_scc1 L_ck_5
    s_cmp_eq_u32 s83, 0
    s_cbranch_scc1 L_ck_5
    s_sub_u32 s83, s83, 1
    s_sleep 1
    s_branch L_cs_6
L_ck_5:
    ds_read_b128 v[48:51], v2 offset:16384
    s_cmp_gt_u32 s71, 3
    s_cbranch_scc1 L_ck_7
L_cs_8:
    ds_read_b32 v39, v26 offset:25856
    s_waitcnt lgkmcnt(0)
    v_readfirstlane_b32 s71, v39
    s_nop 0
    s_cmp_gt_u32 s71, 3
    s_cbranch_scc1 L_ck_7
    s_cmp_eq_u32 s83, 0
    s_cbranch_scc1 L_ck_7
    s_sub_u32 s83, s83, 1
    s_sleep 1
    s_branch L_cs_8
L_ck_7:
    ds_read_b128 v[52:55], v2 offset:24576
    v_mov_b32 v38, 4
    s_waitcnt lgkmcnt(0)
    s_mov_b64 exec, 1
    ds_write_b32 v27, v38 offset:25600
    s_mov_b64 exec, -1
    s_waitcnt vmcnt(0)
    v_lshlrev_b32 v129, 16, v128
    v_lshlrev_b32 v131, 16, v130
    v_dot2c_f32_bf16_dpp v136, v128, v104 row_newbcast:0 row_mask:0xf bank_mask:0xf
    v_dot2c_f32_bf16_dpp v137, v129, v104 row_newbcast:0 row_mask:0xf bank_mask:0xf
    v_dot2c_f32_bf16_dpp v138, v128, v105 row_newbcast:0 row_mask:0xf bank_mask:0xf
    v_dot2c_f32_bf16_dpp v139, v129, v105 row_newbcast:0 row_mask:0xf bank_mask:0xf
    v_dot2c_f32_bf16_dpp v140, v128, v106 row_newbcast:0 row_mask:0xf bank_mask:0xf
    v_dot2c_f32_bf16_dpp v141, v129, v106 row_newbcast:0 row_mask:0xf bank_mask:0xf
    v_dot2c_f32_bf16_dpp v142, v128, v107 row_newbcast:0 row_mask:0xf bank_mask:0xf
    v_dot2c_f32_bf16_dpp v143, v129, v107 row_newbcast:0 row_mask:0xf bank_mask:0xf
    v_dot2c_f32_bf16_dpp v136, v128, v108 row_newbcast:1 row_mask:0xf bank_mask:0xf
    v_dot2c_f32_bf16_dpp v137, v129, v108 row_newbcast:1 row_mask:0xf bank_mask:0xf
    v_dot2c_f32_bf16_dpp v138, v128, v109 row_newbcast:1 row_mask:0xf bank_mask:0xf
    v_dot2c_f32_bf16_dpp v139, v129, v109 row_newbcast:1 row_mask:0xf bank_mask:0xf
    v_dot2c_f32_bf16_dpp v140, v128, v110 row_newbcast:1 row_mask:0xf bank_mask:0xf
    v_dot2c_f32_bf16_dpp v141, v129, v110 row_newbcast:1 row_mask:0xf bank_mask:0xf
    v_dot2c_f32_bf16_dpp v142, v128, v111 row_newbcast:1 row_mask:0xf bank_mask:0xf
    v_dot2c_f32_bf16_dpp v143, v129, v111 row_newbcast:1 row_mask:0xf bank_mask:0xf
    v_dot2c_f32_bf16_dpp v136, v128, v112 row_newbcast:2 row_mask:0xf bank_mask:0xf
    v_dot2c_f32_bf16_dpp v137, v129, v112 row_newbcast:2 row_mask:0xf bank_mask:0xf
    v_dot2c_f32_bf16_dpp v138, v128, v113 row_newbcast:2 row_mask:0xf bank_mask:0xf
    v_dot2c_f32_bf16_dpp v139, v129, v113 row_newbcast:2 row_mask:0xf bank_mask:0xf
    v_dot2c_f32_bf16_dpp v140, v128, v114 row_newbcast:2 row_mask:0xf bank_mask:0xf
    v_dot2c_f32_bf16_dpp v141, v129, v114 row_newbcast:2 row_mask:0xf bank_mask:0xf
    v_dot2c_f32_bf16_dpp v142, v128, v115 row_newbcast:2 row_mask:0xf bank_mask:0xf
    v_dot2c_f32_bf16_dpp v143, v129, v115 row_newbcast:2 row_mask:0xf bank_mask:0xf
    v_dot2c_f32_bf16_dpp v136, v128, v116 row_newbcast:3 row_mask:0xf bank_mask:0xf
    v_dot2c_f32_bf16_dpp v137, v129, v116 row_newbcast:3 row_mask:0xf bank_mask:0xf
    v_dot2c_f32_bf16_dpp v138, v128, v117 row_newbcast:3 row_mask:0xf bank_mask:0xf
    v_dot2c_f32_bf16_dpp v139, v129, v117 row_newbcast:3 row_mask:0xf bank_mask:0xf
    v_dot2c_f32_bf16_dpp v140, v128, v118 row_newbcast:3 row_mask:0xf bank_mask:0xf
    v_dot2c_f32_bf16_dpp v141, v129, v118 row_newbcast:3 row_mask:0xf bank_mask:0xf
    v_dot2c_f32_bf16_dpp v142, v128, v119 row_newbcast:3 row_mask:0xf bank_mask:0xf
    v_dot2c_f32_bf16_dpp v143, v129, v119 row_newbcast:3 row_mask:0xf bank_mask:0xf
    v_dot2c_f32_bf16_dpp v144, v130, v120 row_newbcast:0 row_mask:0xf bank_mask:0xf
    v_dot2c_f32_bf16_dpp v145, v131, v120 row_newbcast:0 row_mask:0xf bank_mask:0xf
    v_dot2c_f32_bf16_dpp v146, v130, v121 row_newbcast:0 row_mask:0xf bank_mask:0xf
    v_dot2c_f32_bf16_dpp v147, v131, v121 row_newbcast:0 row_mask:0xf bank_mask:0xf
    v_dot2c_f32_bf16_dpp v148, v130, v122 row_newbcast:0 row_mask:0xf bank_mask:0xf
    v_dot2c_f32_bf16_dpp v149, v131, v122 row_newbcast:0 row_mask:0xf bank_mask:0xf
    v_dot2c_f32_bf16_dpp v150, v130, v123 row_newbcast:0 row_mask:0xf bank_mask:0xf
    v_dot2c_f32_bf16_dpp v151, v131, v123 row_newbcast:0 row_mask:0xf bank_mask:0xf
    v_dot2c_f32_bf16_dpp v144, v130, v124 row_newbcast:1 row_mask:0xf bank_mask:0xf
    v_dot2c_f32_bf16_dpp v145, v131, v124 row_newbcast:1 row_mask:0xf bank_mask:0xf
    v_dot2c_f32_bf16_dpp v146, v130, v125 row_newbcast:1 row_mask:0xf bank_mask:0xf
    v_dot2c_f32_bf16_dpp v147, v131, v125 row_newbcast:1 row_mask:0xf bank_mask:0xf
    v_dot2c_f32_bf16_dpp v148, v130, v126 row_newbcast:1 row_mask:0xf bank_mask:0xf
    v_dot2c_f32_bf16_dpp v149, v131, v126 row_newbcast:1 row_mask:0xf bank_mask:0xf
    v_dot2c_f32_bf16_dpp v150, v130, v127 row_newbcast:1 row_mask:0xf bank_mask:0xf
    v_dot2c_f32_bf16_dpp v151, v131, v127 row_newbcast:1 row_mask:0xf bank_mask:0xf
    v_permlane32_swap_b32 v136, v140
    v_permlane32_swap_b32 v137, v141
    v_permlane32_swap_b32 v138, v142
    v_permlane32_swap_b32 v139, v143
    v_permlane32_swap_b32 v144, v148
    v_permlane32_swap_b32 v145, v149
    v_permlane32_swap_b32 v146, v150
    v_permlane32_swap_b32 v147, v151
    v_add_f32 v136, v136, v140
    v_add_f32 v137, v137, v141
    v_add_f32 v138, v138, v142
    v_add_f32 v139, v139, v143
    v_add_f32 v144, v144, v148
    v_add_f32 v145, v145, v149
    v_add_f32 v146, v146, v150
    v_add_f32 v147, v147, v151
    ds_write_b128 v30, v[136:139] offset:1024
    v_permlane16_swap_b32 v144, v146
    v_permlane16_swap_b32 v145, v147
    v_add_f32 v144, v144, v146
    v_add_f32 v145, v145, v147
    ds_write_b64 v32, v[144:145] offset:2048
    v_mov_b32 v34, 96
    v_mov_b32 v35, 1
    s_waitcnt lgkmcnt(0)
    s_mov_b64 exec, 1
    ds_add_rtn_u32 v35, v34, v35
    s_mov_b64 exec, -1
    s_waitcnt lgkmcnt(0)
    v_readfirstlane_b32 s76, v35
    s_add_u32 s68, s68, 8
    s_add_u32 s69, s69, 1
    s_getreg_b32 s29, hwreg(HW_REG_XCC_ID, 0, 3)
    s_andn2_b32 s3, s68, 7
    s_or_b32 s29, s29, s3
    s_cmp_lg_u32 s76, 6
    s_cbranch_scc1 L_k2
    v_lshlrev_b32 v28, 2, v1
    ds_read_b32 v104, v28 offset:1024
    ds_read_b32 v105, v28 offset:2560
    ds_read_b32 v106, v28 offset:4096
    ds_read_b32 v107, v28 offset:5632
    ds_read_b32 v108, v28 offset:7168
    ds_read_b32 v109, v28 offset:8704
    ds_read_b32 v110, v28 offset:10240
    ds_read_b32 v112, v28 offset:1536
    ds_read_b32 v113, v28 offset:3072
    ds_read_b32 v114, v28 offset:4608
    ds_read_b32 v115, v28 offset:6144
    ds_read_b32 v116, v28 offset:7680
    ds_read_b32 v117, v28 offset:9216
    ds_read_b32 v118, v28 offset:10752
    ds_read_b32 v120, v28 offset:2048
    ds_read_b32 v121, v28 offset:3584
    ds_read_b32 v122, v28 offset:5120
    ds_read_b32 v123, v28 offset:6656
    ds_read_b32 v124, v28 offset:8192
    ds_read_b32 v125, v28 offset:9728
    ds_read_b32 v126, v28 offset:11264
    ds_read_b32 v128, v28 offset:1280
    ds_read_b32 v129, v28 offset:2816
    ds_read_b32 v130, v28 offset:4352
    ds_read_b32 v131, v28 offset:5888
    ds_read_b32 v132, v28 offset:7424
    ds_read_b32 v133, v28 offset:8960
    ds_read_b32 v134, v28 offset:10496
    ds_read_b32 v136, v28 offset:1792
    ds_read_b32 v137, v28 offset:3328
    ds_read_b32 v138, v28 offset:4864
    ds_read_b32 v139, v28 offset:6400
    ds_read_b32 v140, v28 offset:7936
    ds_read_b32 v141, v28 offset:9472
    ds_read_b32 v142, v28 offset:11008
    ds_read_b32 v144, v28 offset:2304
    ds_read_b32 v145, v28 offset:3840
    ds_read_b32 v146, v28 offset:5376
    ds_read_b32 v147, v28 offset:6912
    ds_read_b32 v148, v28 offset:8448
    ds_read_b32 v149, v28 offset:9984
    ds_read_b32 v150, v28 offset:11520
    s_lshl_b32 s76, s2, 13
    v_lshl_add_u32 v29, v1, 4, s76
    v_mov_b32 v11, s29
    v_mov_b32 v15, s29
    s_waitcnt lgkmcnt(0)
    v_add_f32 v104, v104, v105
    v_add_f32 v106, v106, v107
    v_add_f32 v108, v108, v109
    v_add_f32 v112, v112, v113
    v_add_f32 v114, v114, v115
    v_add_f32 v116, v116, v117
    v_add_f32 v120, v120, v121
    v_add_f32 v122, v122, v123
    v_add_f32 v124, v124, v125
    v_add_f32 v104, v104, v106
    v_add_f32 v108, v108, v110
    v_add_f32 v112, v112, v114
    v_add_f32 v116, v116, v118
    v_add_f32 v120, v120, v122
    v_add_f32 v124, v124, v126
    v_add_f32 v8, v104, v108
    v_add_f32 v9, v112, v116
    v_add_f32 v10, v120, v124
    buffer_store_dwordx4 v[8:11], v29, s[64:67], 0 offen offset:0
    v_add_f32 v128, v128, v129
    v_add_f32 v130, v130, v131
    v_add_f32 v132, v132, v133
    v_add_f32 v136, v136, v137
    v_add_f32 v138, v138, v139
    v_add_f32 v140, v140, v141
    v_add_f32 v144, v144, v145
    v_add_f32 v146, v146, v147
    v_add_f32 v148, v148, v149
    v_add_f32 v128, v128, v130
    v_add_f32 v132, v132, v134
    v_add_f32 v136, v136, v138
    v_add_f32 v140, v140, v142
    v_add_f32 v144, v144, v146
    v_add_f32 v148, v148, v150
    v_add_f32 v12, v128, v132
    v_add_f32 v13, v136, v140
    v_add_f32 v14, v144, v148
    buffer_store_dwordx4 v[12:15], v29, s[64:67], 0 offen offset:1024
    s_branch L_k2
L_svc:
    s_mov_b32 s64, s26
    s_mov_b32 s65, s27
    s_mov_b32 s66, 4194560
    s_mov_b32 s67, 0x20000
    s_mov_b32 s52, s4
    s_mov_b32 s53, s5
    s_mov_b32 s54, 1792
    s_mov_b32 s55, 0x20000
    s_mov_b32 s56, s20
    s_mov_b32 s57, s21
    s_mov_b32 s58, 896
    s_mov_b32 s59, 0x20000
    s_mul_i32 s3, s73, 896
    v_lshlrev_b32 v35, 4, v1
    v_add_u32 v36, s3, v35
    v_cmp_gt_u32 vcc, 56, v1
    v_mov_b32 v34, 0x10000
    s_nop 0
    v_cndmask_b32 v36, v34, v36, vcc
    buffer_load_dwordx4 v[104:107], v36, s[52:55], 0 offen
    buffer_load_dwordx4 v[108:111], v35, s[56:59], 0 offen
    s_waitcnt lgkmcnt(0)
    s_add_u32 s68, s68, 8
    s_add_u32 s69, s69, 1
    s_getreg_b32 s29, hwreg(HW_REG_XCC_ID, 0, 3)
    s_andn2_b32 s3, s68, 7
    s_or_b32 s29, s29, s3
    s_mov_b32 s44, s12
    s_mov_b32 s45, s13
    s_mov_b32 s46, 3670016
    s_mov_b32 s47, 0x20000
    s_mov_b32 s48, s18
    s_mov_b32 s49, s19
    s_mov_b32 s50, 1605632
    s_mov_b32 s51, 0x20000
    s_mov_b32 s60, s22
    s_mov_b32 s61, s23
    s_mov_b32 s62, 1792
    s_mov_b32 s63, 0x20000
    s_mov_b32 s36, s10
    s_mov_b32 s37, s11
    s_mov_b32 s38, 3670016
    s_mov_b32 s39, 0x20000
    s_mov_b32 s40, s16
    s_mov_b32 s41, s17
    s_mov_b32 s42, 1605632
    s_mov_b32 s43, 0x20000
    s_mov_b32 s32, s8
    s_mov_b32 s33, s9
    s_mov_b32 s34, 67108864
    s_mov_b32 s35, 0x20000
    s_cmp_gt_u32 s71, 0
    s_cbranch_scc1 L_ck_9
L_cs_10:
    ds_read_b32 v39, v26 offset:25856
    s_waitcnt lgkmcnt(0)
    v_readfirstlane_b32 s71, v39
    s_nop 0
    s_cmp_gt_u32 s71, 0
    s_cbranch_scc1 L_ck_9
    s_cmp_eq_u32 s83, 0
    s_cbranch_scc1 L_ck_9
    s_sub_u32 s83, s83, 1
    s_sleep 1
    s_branch L_cs_10
L_ck_9:
    ds_read_b128 v[40:43], v2 offset:0
    s_cmp_gt_u32 s71, 1
    s_cbranch_scc1 L_ck_11
L_cs_12:
    ds_read_b32 v39, v26 offset:25856
    s_waitcnt lgkmcnt(0)
    v_readfirstlane_b32 s71, v39
    s_nop 0
    s_cmp_gt_u32 s71, 1
    s_cbranch_scc1 L_ck_11
    s_cmp_eq_u32 s83, 0
    s_cbranch_scc1 L_ck_11
    s_sub_u32 s83, s83, 1
    s_sleep 1
    s_branch L_cs_12
L_ck_11:
    ds_read_b128 v[44:47], v2 offset:8192
    v_mov_b32 v38, 2
    s_waitcnt lgkmcnt(0)
    s_mov_b64 exec, 1
    ds_write_b32 v27, v38 offset:25600
    s_mov_b64 exec, -1
    s_cmp_gt_u32 s71, 2
    s_cbranch_scc1 L_ck_13
L_cs_14:
    ds_read_b32 v39, v26 offset:25856
    s_waitcnt lgkmcnt(0)
    v_readfirstlane_b32 s71, v39
    s_nop 0
    s_cmp_gt_u32 s71, 2
    s_cbranch_scc1 L_ck_13
    s_cmp_eq_u32 s83, 0
    s_cbranch_scc1 L_ck_13
    s_sub_u32 s83, s83, 1
    s_sleep 1
    s_branch L_cs_14
L_ck_13:
    ds_read_b128 v[48:51], v2 offset:16384
    s_cmp_gt_u32 s71, 3
    s_cbranch_scc1 L_ck_15
L_cs_16:
    ds_read_b32 v39, v26 offset:25856
    s_waitcnt lgkmcnt(0)
    v_readfirstlane_b32 s71, v39
    s_nop 0
    s_cmp_gt_u32 s71, 3
    s_cbranch_scc1 L_ck_15
    s_cmp_eq_u32 s83, 0
    s_cbranch_scc1 L_ck_15
    s_sub_u32 s83, s83, 1
    s_sleep 1
    s_branch L_cs_16
L_ck_15:
    ds_read_b128 v[52:55], v2 offset:24576
    v_mov_b32 v38, 4
    s_waitcnt lgkmcnt(0)
    s_mov_b64 exec, 1
    ds_write_b32 v27, v38 offset:25600
    s_mov_b64 exec, -1
    s_waitcnt vmcnt(0)
    v_mov_b32 v28, 0
    v_lshlrev_b32 v29, 16, v104
    v_lshlrev_b32 v30, 16, v108
    v_and_b32 v31, 0xffff0000, v104
    v_and_b32 v32, 0xffff0000, v108
    v_mul_f32 v29, v29, v30
    v_mul_f32 v31, v31, v32
    v_cvt_pk_bf16_f32 v29, v29, v31
    v_lshlrev_b32 v30, 16, v29
    v_and_b32 v31, 0xffff0000, v29
    v_add_f32 v28, v28, v30
    v_add_f32 v28, v28, v31
    v_lshlrev_b32 v29, 16, v105
    v_lshlrev_b32 v30, 16, v109
    v_and_b32 v31, 0xffff0000, v105
    v_and_b32 v32, 0xffff0000, v109
    v_mul_f32 v29, v29, v30
    v_mul_f32 v31, v31, v32
    v_cvt_pk_bf16_f32 v29, v29, v31
    v_lshlrev_b32 v30, 16, v29
    v_and_b32 v31, 0xffff0000, v29
    v_add_f32 v28, v28, v30
    v_add_f32 v28, v28, v31
    v_lshlrev_b32 v29, 16, v106
    v_lshlrev_b32 v30, 16, v110
    v_and_b32 v31, 0xffff0000, v106
    v_and_b32 v32, 0xffff0000, v110
    v_mul_f32 v29, v29, v30
    v_mul_f32 v31, v31, v32
    v_cvt_pk_bf16_f32 v29, v29, v31
    v_lshlrev_b32 v30, 16, v29
    v_and_b32 v31, 0xffff0000, v29
    v_add_f32 v28, v28, v30
    v_add_f32 v28, v28, v31
    v_lshlrev_b32 v29, 16, v107
    v_lshlrev_b32 v30, 16, v111
    v_and_b32 v31, 0xffff0000, v107
    v_and_b32 v32, 0xffff0000, v111
    v_mul_f32 v29, v29, v30
    v_mul_f32 v31, v31, v32
    v_cvt_pk_bf16_f32 v29, v29, v31
    v_lshlrev_b32 v30, 16, v29
    v_and_b32 v31, 0xffff0000, v29
    v_add_f32 v28, v28, v30
    v_add_f32 v28, v28, v31
    s_nop 1
    v_add_f32_dpp v28, v28, v28 quad_perm:[1,0,3,2] row_mask:0xf bank_mask:0xf
    s_nop 1
    v_add_f32_dpp v28, v28, v28 quad_perm:[2,3,0,1] row_mask:0xf bank_mask:0xf
    s_nop 1
    v_add_f32_dpp v28, v28, v28 row_half_mirror row_mask:0xf bank_mask:0xf
    s_nop 1
    v_add_f32_dpp v28, v28, v28 row_ror:8 row_mask:0xf bank_mask:0xf
    v_mov_b32 v29, v28
    s_nop 1
    v_permlane16_swap_b32 v28, v29
    v_add_f32 v28, v28, v29
    v_mov_b32 v29, v28
    s_nop 1
    v_permlane32_swap_b32 v28, v29
    v_add_f32 v28, v28, v29
    v_cvt_pk_bf16_f32 v28, 0, v28
    v_mul_f32 v28, 0xbfb8aa3b, v28
    v_exp_f32 v28, v28
    s_nop 0
    v_add_f32 v28, 1.0, v28
    v_rcp_f32 v28, v28
    s_nop 0
    v_cvt_pk_bf16_f32 v28, 0, v28
    v_mov_b32 v29, 116
    ds_write_b32 v29, v28
L_k2:
    s_mov_b32 s78, 0xcccccccc
    s_mov_b32 s79, 0xcccccccc
    s_mov_b32 s80, 0xaaaaaaaa
    s_mov_b32 s81, 0xaaaaaaaa
    s_lshl_b32 s70, s2, 13
    v_and_b32 v29, 7, v1
    v_lshrrev_b32 v28, 3, v1
    v_lshlrev_b32 v25, 5, v29
    v_lshrrev_b32 v30, 5, v1
    v_lshl_add_u32 v25, v30, 4, v25
    v_bfe_u32 v30, v1, 4, 1
    v_lshl_add_u32 v25, v30, 3, v25
    v_bfe_u32 v30, v1, 3, 1
    v_lshl_add_u32 v25, v30, 2, v25
    s_lshl_b32 s77, s75, 8
    v_add_u32 v25, s77, v25
    s_and_b32 s76, s2, 31
    s_lshl_b32 s76, s76, 13
    s_add_u32 s76, s76, 4096
    v_lshlrev_b32 v4, 18, v29
    v_add_u32 v4, s76, v4
    v_lshl_add_u32 v5, v28, 4, v4
    s_lshl_b32 s77, s75, 7
    v_add_u32 v5, s77, v5
    s_lshl_b32 s77, s74, 7
    v_lshl_add_u32 v29, v29, 4, s77
    s_lshl_b32 s76, s72, 8
    s_lshl_b32 s77, s75, 5
    s_add_u32 s76, s76, s77
    v_lshl_add_u32 v30, v28, 2, s76
    v_mul_u32_u24 v30, 896, v30
    v_add_u32 v6, v30, v29
    s_lshr_b32 s76, s76, 1
    v_lshl_add_u32 v30, v28, 1, s76
    v_mul_u32_u24 v30, 896, v30
    v_add_u32 v7, v30, v29
    v_and_b32 v28, 31, v1
    v_lshlrev_b32 v3, 4, v28
    s_and_b32 s76, s2, 31
    s_lshl_b32 s76, s76, 13
    s_lshl_b32 s77, s75, 18
    s_add_u32 s76, s76, s77
    v_lshl_add_u32 v8, v1, 4, s76
    v_lshl_add_u32 v12, v1, 4, s70
    s_mul_i32 s77, s75, 1536
    v_lshl_add_u32 v9, v1, 2, s77
    s_cmp_gt_u32 s71, 4
    s_cbranch_scc1 L_ck_17
L_cs_18:
    ds_read_b32 v39, v26 offset:25856
    s_waitcnt lgkmcnt(0)
    v_readfirstlane_b32 s71, v39
    s_nop 0
    s_cmp_gt_u32 s71, 4
    s_cbranch_scc1 L_ck_17
    s_cmp_eq_u32 s83, 0
    s_cbranch_scc1 L_ck_17
    s_sub_u32 s83, s83, 1
    s_sleep 1
    s_branch L_cs_18
L_ck_17:
    ds_read_b128 v[56:59], v2 offset:32768
    s_cmp_gt_u32 s71, 5
    s_cbranch_scc1 L_ck_19
L_cs_20:
    ds_read_b32 v39, v26 offset:25856
    s_waitcnt lgkmcnt(0)
    v_readfirstlane_b32 s71, v39
    s_nop 0
    s_cmp_gt_u32 s71, 5
    s_cbranch_scc1 L_ck_19
    s_cmp_eq_u32 s83, 0
    s_cbranch_scc1 L_ck_19
    s_sub_u32 s83, s83, 1
    s_sleep 1
    s_branch L_cs_20
L_ck_19:
    ds_read_b128 v[60:63], v2 offset:40960
    v_mov_b32 v38, 6
    s_waitcnt lgkmcnt(0)
    s_mov_b64 exec, 1
    ds_write_b32 v27, v38 offset:25600
    s_mov_b64 exec, -1
    s_cmp_gt_u32 s71, 6
    s_cbranch_scc1 L_ck_21
L_cs_22:
    ds_read_b32 v39, v26 offset:25856
    s_waitcnt lgkmcnt(0)
    v_readfirstlane_b32 s71, v39
    s_nop 0
    s_cmp_gt_u32 s71, 6
    s_cbranch_scc1 L_ck_21
    s_cmp_eq_u32 s83, 0
    s_cbranch_scc1 L_ck_21
    s_sub_u32 s83, s83, 1
    s_sleep 1
    s_branch L_cs_22
L_ck_21:
    ds_read_b128 v[64:67], v2 offset:49152
    s_cmp_gt_u32 s71, 7
    s_cbranch_scc1 L_ck_23
L_cs_24:
    ds_read_b32 v39, v26 offset:25856
    s_waitcnt lgkmcnt(0)
    v_readfirstlane_b32 s71, v39
    s_nop 0
    s_cmp_gt_u32 s71, 7
    s_cbranch_scc1 L_ck_23
    s_cmp_eq_u32 s83, 0
    s_cbranch_scc1 L_ck_23
    s_sub_u32 s83, s83, 1
    s_sleep 1
    s_branch L_cs_24
L_ck_23:
    ds_read_b128 v[68:71], v2 offset:57344
    v_mov_b32 v38, 8
    s_waitcnt lgkmcnt(0)
    s_mov_b64 exec, 1
    ds_write_b32 v27, v38 offset:25600
    s_mov_b64 exec, -1
    s_cmp_gt_u32 s71, 8
    s_cbranch_scc1 L_ck_25
L_cs_26:
    ds_read_b32 v39, v26 offset:25856
    s_waitcnt lgkmcnt(0)
    v_readfirstlane_b32 s71, v39
    s_nop 0
    s_cmp_gt_u32 s71, 8
    s_cbranch_scc1 L_ck_25
    s_cmp_eq_u32 s83, 0
    s_cbranch_scc1 L_ck_25
    s_sub_u32 s83, s83, 1
    s_sleep 1
    s_branch L_cs_26
L_ck_25:
    ds_read_b128 v[72:75], v0 offset:0
    s_cmp_gt_u32 s71, 9
    s_cbranch_scc1 L_ck_27
L_cs_28:
    ds_read_b32 v39, v26 offset:25856
    s_waitcnt lgkmcnt(0)
    v_readfirstlane_b32 s71, v39
    s_nop 0
    s_cmp_gt_u32 s71, 9
    s_cbranch_scc1 L_ck_27
    s_cmp_eq_u32 s83, 0
    s_cbranch_scc1 L_ck_27
    s_sub_u32 s83, s83, 1
    s_sleep 1
    s_branch L_cs_28
L_ck_27:
    ds_read_b128 v[76:79], v0 offset:8192
    v_mov_b32 v38, 10
    s_waitcnt lgkmcnt(0)
    s_mov_b64 exec, 1
    ds_write_b32 v27, v38 offset:25600
    s_mov_b64 exec, -1
    buffer_load_dwordx4 v[136:139], v8, s[64:67], 0 offen offset:0 sc1
    buffer_load_dwordx4 v[140:143], v8, s[64:67], 0 offen offset:1024 sc1
    s_cmp_gt_u32 s71, 10
    s_cbranch_scc1 L_ck_29
L_cs_30:
    ds_read_b32 v39, v26 offset:25856
    s_waitcnt lgkmcnt(0)
    v_readfirstlane_b32 s71, v39
    s_nop 0
    s_cmp_gt_u32 s71, 10
    s_cbranch_scc1 L_ck_29
    s_cmp_eq_u32 s83, 0
    s_cbranch_scc1 L_ck_29
    s_sub_u32 s83, s83, 1
    s_sleep 1
    s_branch L_cs_30
L_ck_29:
    ds_read_b128 v[80:83], v0 offset:16384
    s_cmp_gt_u32 s71, 11
    s_cbranch_scc1 L_ck_31
L_cs_32:
    ds_read_b32 v39, v26 offset:25856
    s_waitcnt lgkmcnt(0)
    v_readfirstlane_b32 s71, v39
    s_nop 0
    s_cmp_gt_u32 s71, 11
    s_cbranch_scc1 L_ck_31
    s_cmp_eq_u32 s83, 0
    s_cbranch_scc1 L_ck_31
    s_sub_u32 s83, s83, 1
    s_sleep 1
    s_branch L_cs_32
L_ck_31:
    ds_read_b128 v[84:87], v0 offset:24576
    v_mov_b32 v38, 12
    s_waitcnt lgkmcnt(0)
    s_mov_b64 exec, 1
    ds_write_b32 v27, v38 offset:25600
    s_mov_b64 exec, -1
    s_waitcnt vmcnt(0)
    s_mov_b32 s30, 0
L_g:
    v_xor_b32 v10, s29, v139
    v_bitop3_b32 v10, v10, s29, v143 bitop3:0xf6
    v_cmp_ne_u32 vcc, 0, v10
    s_cbranch_vccz L_gd
    v_cmp_lt_u32 vcc, 7, v10
    s_cbranch_vccz L_grem
    s_cmp_eq_u32 s83, 0
    s_cbranch_scc1 L_gd
    s_sub_u32 s83, s83, 1
    s_add_u32 s30, s30, 1
    s_and_b32 s3, s30, 15
    s_cbranch_scc0 L_gfb
    buffer_load_dwordx4 v[136:139], v8, s[64:67], 0 offen offset:0 sc1
    buffer_load_dwordx4 v[140:143], v8, s[64:67], 0 offen offset:1024 sc1
    s_waitcnt vmcnt(0)
    s_branch L_g
L_gfb:
L_wt_33:
    buffer_load_dwordx4 v[144:147], v12, s[64:67], 0 offen offset:0 sc1
    buffer_load_dwordx4 v[148:151], v12, s[64:67], 0 offen offset:1024 sc1
    s_waitcnt vmcnt(0)
    v_xor_b32 v10, s29, v147
    v_bitop3_b32 v10, v10, s29, v151 bitop3:0xf6
    v_cmp_ne_u32 vcc, 0, v10
    s_cbranch_vccz L_wtd_34s
    s_branch L_wtd_34
L_wtd_34s:
    buffer_store_dwordx4 v[144:147], v12, s[64:67], 0 offen offset:2048 sc1
    buffer_store_dwordx4 v[148:151], v12, s[64:67], 0 offen offset:3072 sc1
L_wtd_34:
    buffer_load_dwordx4 v[136:139], v8, s[64:67], 0 offen offset:2048 sc1
    buffer_load_dwordx4 v[140:143], v8, s[64:67], 0 offen offset:3072 sc1
    s_waitcnt vmcnt(0)
    s_branch L_g
L_grem:
    v_mov_b32 v10, 120
    v_mov_b32 v11, 1
    ds_write_b32 v10, v11
L_wt_35:
    buffer_load_dwordx4 v[144:147], v12, s[64:67], 0 offen offset:0 sc1
    buffer_load_dwordx4 v[148:151], v12, s[64:67], 0 offen offset:1024 sc1
    s_waitcnt vmcnt(0)
    v_xor_b32 v10, s29, v147
    v_bitop3_b32 v10, v10, s29, v151 bitop3:0xf6
    v_cmp_ne_u32 vcc, 0, v10
    s_cbranch_vccz L_wtd_36s
    s_cmp_eq_u32 s83, 0
    s_cbranch_scc1 L_wtd_36
    s_sub_u32 s83, s83, 1
    s_branch L_wt_35
L_wtd_36s:
    buffer_store_dwordx4 v[144:147], v12, s[64:67], 0 offen offset:2048 sc1
    buffer_store_dwordx4 v[148:151], v12, s[64:67], 0 offen offset:3072 sc1
L_wtd_36:
L_gd:
    ds_write_b32 v9, v136 offset:13312
    ds_write_b32 v9, v137 offset:13824
    ds_write_b32 v9, v138 offset:14336
    ds_write_b32 v9, v140 offset:13568
    ds_write_b32 v9, v141 offset:14080
    ds_write_b32 v9, v142 offset:14592
    v_mov_b32 v10, 104
    v_mov_b32 v11, 1
    s_waitcnt lgkmcnt(0)
    s_mov_b64 exec, 1
    ds_add_rtn_u32 v11, v10, v11
    s_mov_b64 exec, -1
    s_waitcnt lgkmcnt(0)
    v_readfirstlane_b32 s76, v11
    s_nop 0
    s_cmp_lg_u32 s76, 7
    s_cbranch_scc1 L_noq
    v_lshlrev_b32 v9, 3, v1
    v_lshlrev_b32 v8, 2, v1
    v_mov_b32 v11, 1
    v_mov_b32 v12, 108
    ds_read_b64 v[136:137], v9 offset:13312
    ds_read_b64 v[138:139], v9 offset:14848
    ds_read_b64 v[140:141], v9 offset:16384
    ds_read_b64 v[142:143], v9 offset:17920
    ds_read_b64 v[144:145], v9 offset:19456
    ds_read_b64 v[146:147], v9 offset:20992
    ds_read_b64 v[148:149], v9 offset:22528
    ds_read_b64 v[150:151], v9 offset:24064
    ds_read_b64 v[152:153], v9 offset:13824
    ds_read_b64 v[154:155], v9 offset:15360
    ds_read_b64 v[156:157], v9 offset:16896
    ds_read_b64 v[158:159], v9 offset:18432
    ds_read_b64 v[160:161], v9 offset:19968
    ds_read_b64 v[162:163], v9 offset:21504
    ds_read_b64 v[164:165], v9 offset:23040
    ds_read_b64 v[166:167], v9 offset:24576
    s_waitcnt lgkmcnt(0)
    v_add_f32 v136, v136, v138
    v_add_f32 v137, v137, v139
    v_add_f32 v140, v140, v142
    v_add_f32 v141, v141, v143
    v_add_f32 v144, v144, v146
    v_add_f32 v145, v145, v147
    v_add_f32 v148, v148, v150
    v_add_f32 v149, v149, v151
    v_add_f32 v136, v136, v140
    v_add_f32 v137, v137, v141
    v_add_f32 v144, v144, v148
    v_add_f32 v145, v145, v149
    v_add_f32 v136, v136, v144
    v_add_f32 v137, v137, v145
    v_cvt_pk_bf16_f32 v13, v136, v137
    ds_write_b32 v8, v13 offset:128
    ds_read_b64 v[136:137], v9 offset:14336
    ds_read_b64 v[138:139], v9 offset:15872
    ds_read_b64 v[140:141], v9 offset:17408
    ds_read_b64 v[142:143], v9 offset:18944
    ds_read_b64 v[144:145], v9 offset:20480
    ds_read_b64 v[146:147], v9 offset:22016
    ds_read_b64 v[148:149], v9 offset:23552
    ds_read_b64 v[150:151], v9 offset:25088
    s_waitcnt lgkmcnt(0)
    v_add_f32 v152, v152, v154
    v_add_f32 v153, v153, v155
    v_add_f32 v156, v156, v158
    v_add_f32 v157, v157, v159
    v_add_f32 v160, v160, v162
    v_add_f32 v161, v161, v163
    v_add_f32 v164, v164, v166
    v_add_f32 v165, v165, v167
    v_add_f32 v152, v152, v156
    v_add_f32 v153, v153, v157
    v_add_f32 v160, v160, v164
    v_add_f32 v161, v161, v165
    v_add_f32 v152, v152, v160
    v_add_f32 v153, v153, v161
    v_cvt_pk_bf16_f32 v14, v152, v153
    ds_write_b32 v8, v14 offset:384
    s_waitcnt lgkmcnt(0)
    v_add_f32 v136, v136, v138
    v_add_f32 v137, v137, v139
    v_add_f32 v140, v140, v142
    v_add_f32 v141, v141, v143
    v_add_f32 v144, v144, v146
    v_add_f32 v145, v145, v147
    v_add_f32 v148, v148, v150
    v_add_f32 v149, v149, v151
    v_add_f32 v136, v136, v140
    v_add_f32 v137, v137, v141
    v_add_f32 v144, v144, v148
    v_add_f32 v145, v145, v149
    v_add_f32 v136, v136, v144
    v_add_f32 v137, v137, v145
    v_maximum3_f32 v136, v136, 0, 0
    v_maximum3_f32 v137, v137, 0, 0
    v_cvt_pk_bf16_f32 v15, v136, v137
    ds_write_b32 v8, v15 offset:640
    s_waitcnt lgkmcnt(0)
    ds_write_b32 v12, v11
L_noq:
    s_cmp_lg_u32 s75, 0
    s_cbranch_scc1 L_noclr
    s_add_u32 s76, s70, 4096
    v_lshl_add_u32 v28, v1, 4, s76
    v_mov_b32 v8, -1
    v_mov_b32 v9, -1
    v_mov_b32 v10, -1
    v_mov_b32 v11, -1
    buffer_store_dwordx4 v[8:11], v28, s[64:67], 0 offen
L_noclr:
    s_cmp_gt_u32 s71, 12
    s_cbranch_scc1 L_ck_37
L_cs_38:
    ds_read_b32 v39, v26 offset:25856
    s_waitcnt lgkmcnt(0)
    v_readfirstlane_b32 s71, v39
    s_nop 0
    s_cmp_gt_u32 s71, 12
    s_cbranch_scc1 L_ck_37
    s_cmp_eq_u32 s83, 0
    s_cbranch_scc1 L_ck_37
    s_sub_u32 s83, s83, 1
    s_sleep 1
    s_branch L_cs_38
L_ck_37:
    ds_read_b128 v[88:91], v0 offset:32768
    s_cmp_gt_u32 s71, 13
    s_cbranch_scc1 L_ck_39
L_cs_40:
    ds_read_b32 v39, v26 offset:25856
    s_waitcnt lgkmcnt(0)
    v_readfirstlane_b32 s71, v39
    s_nop 0
    s_cmp_gt_u32 s71, 13
    s_cbranch_scc1 L_ck_39
    s_cmp_eq_u32 s83, 0
    s_cbranch_scc1 L_ck_39
    s_sub_u32 s83, s83, 1
    s_sleep 1
    s_branch L_cs_40
L_ck_39:
    ds_read_b128 v[92:95], v0 offset:40960
    v_mov_b32 v38, 14
    s_waitcnt lgkmcnt(0)
    s_mov_b64 exec, 1
    ds_write_b32 v27, v38 offset:25600
    s_mov_b64 exec, -1
    s_cmp_gt_u32 s71, 14
    s_cbranch_scc1 L_ck_41
L_cs_42:
    ds_read_b32 v39, v26 offset:25856
    s_waitcnt lgkmcnt(0)
    v_readfirstlane_b32 s71, v39
    s_nop 0
    s_cmp_gt_u32 s71, 14
    s_cbranch_scc1 L_ck_41
    s_cmp_eq_u32 s83, 0
    s_cbranch_scc1 L_ck_41
    s_sub_u32 s83, s83, 1
    s_sleep 1
    s_branch L_cs_42
L_ck_41:
    ds_read_b128 v[96:99], v0 offset:49152
    s_cmp_gt_u32 s71, 15
    s_cbranch_scc1 L_ck_43
L_cs_44:
    ds_read_b32 v39, v26 offset:25856
    s_waitcnt lgkmcnt(0)
    v_readfirstlane_b32 s71, v39
    s_nop 0
    s_cmp_gt_u32 s71, 15
    s_cbranch_scc1 L_ck_43
    s_cmp_eq_u32 s83, 0
    s_cbranch_scc1 L_ck_43
    s_sub_u32 s83, s83, 1
    s_sleep 1
    s_branch L_cs_44
L_ck_43:
    ds_read_b128 v[100:103], v0 offset:57344
    v_mov_b32 v38, 16
    s_waitcnt lgkmcnt(0)
    s_mov_b64 exec, 1
    ds_write_b32 v27, v38 offset:25600
    s_mov_b64 exec, -1
    s_cmp_gt_u32 s71, 16
    s_cbranch_scc1 L_ck_45
L_cs_46:
    ds_read_b32 v39, v26 offset:25856
    s_waitcnt lgkmcnt(0)
    v_readfirstlane_b32 s71, v39
    s_nop 0
    s_cmp_gt_u32 s71, 16
    s_cbranch_scc1 L_ck_45
    s_cmp_eq_u32 s83, 0
    s_cbranch_scc1 L_ck_45
    s_sub_u32 s83, s83, 1
    s_sleep 1
    s_branch L_cs_46
L_ck_45:
    ds_read_b128 v[104:107], v2 offset:0
    s_cmp_gt_u32 s71, 17
    s_cbranch_scc1 L_ck_47
L_cs_48:
    ds_read_b32 v39, v26 offset:25856
    s_waitcnt lgkmcnt(0)
    v_readfirstlane_b32 s71, v39
    s_nop 0
    s_cmp_gt_u32 s71, 17
    s_cbranch_scc1 L_ck_47
    s_cmp_eq_u32 s83, 0
    s_cbranch_scc1 L_ck_47
    s_sub_u32 s83, s83, 1
    s_sleep 1
    s_branch L_cs_48
L_ck_47:
    ds_read_b128 v[108:111], v2 offset:8192
    v_mov_b32 v38, 18
    s_waitcnt lgkmcnt(0)
    s_mov_b64 exec, 1
    ds_write_b32 v27, v38 offset:25600
    s_mov_b64 exec, -1
    s_cmp_gt_u32 s71, 18
    s_cbranch_scc1 L_ck_49
L_cs_50:
    ds_read_b32 v39, v26 offset:25856
    s_waitcnt lgkmcnt(0)
    v_readfirstlane_b32 s71, v39
    s_nop 0
    s_cmp_gt_u32 s71, 18
    s_cbranch_scc1 L_ck_49
    s_cmp_eq_u32 s83, 0
    s_cbranch_scc1 L_ck_49
    s_sub_u32 s83, s83, 1
    s_sleep 1
    s_branch L_cs_50
L_ck_49:
    ds_read_b128 v[112:115], v2 offset:16384
    s_cmp_gt_u32 s71, 19
    s_cbranch_scc1 L_ck_51
L_cs_52:
    ds_read_b32 v39, v26 offset:25856
    s_waitcnt lgkmcnt(0)
    v_readfirstlane_b32 s71, v39
    s_nop 0
    s_cmp_gt_u32 s71, 19
    s_cbranch_scc1 L_ck_51
    s_cmp_eq_u32 s83, 0
    s_cbranch_scc1 L_ck_51
    s_sub_u32 s83, s83, 1
    s_sleep 1
    s_branch L_cs_52
L_ck_51:
    ds_read_b128 v[116:119], v2 offset:24576
    v_mov_b32 v38, 20
    s_waitcnt lgkmcnt(0)
    s_mov_b64 exec, 1
    ds_write_b32 v27, v38 offset:25600
    s_mov_b64 exec, -1
    s_cmp_gt_u32 s71, 20
    s_cbranch_scc1 L_ck_53
L_cs_54:
    ds_read_b32 v39, v26 offset:25856
    s_waitcnt lgkmcnt(0)
    v_readfirstlane_b32 s71, v39
    s_nop 0
    s_cmp_gt_u32 s71, 20
    s_cbranch_scc1 L_ck_53
    s_cmp_eq_u32 s83, 0
    s_cbranch_scc1 L_ck_53
    s_sub_u32 s83, s83, 1
    s_sleep 1
    s_branch L_cs_54
L_ck_53:
    ds_read_b128 v[120:123], v2 offset:32768
    s_cmp_gt_u32 s71, 21
    s_cbranch_scc1 L_ck_55
L_cs_56:
    ds_read_b32 v39, v26 offset:25856
    s_waitcnt lgkmcnt(0)
    v_readfirstlane_b32 s71, v39
    s_nop 0
    s_cmp_gt_u32 s71, 21
    s_cbranch_scc1 L_ck_55
    s_cmp_eq_u32 s83, 0
    s_cbranch_scc1 L_ck_55
    s_sub_u32 s83, s83, 1
    s_sleep 1
    s_branch L_cs_56
L_ck_55:
    ds_read_b128 v[124:127], v2 offset:40960
    v_mov_b32 v38, 22
    s_waitcnt lgkmcnt(0)
    s_mov_b64 exec, 1
    ds_write_b32 v27, v38 offset:25600
    s_mov_b64 exec, -1
    s_cmp_gt_u32 s71, 22
    s_cbranch_scc1 L_ck_57
L_cs_58:
    ds_read_b32 v39, v26 offset:25856
    s_waitcnt lgkmcnt(0)
    v_readfirstlane_b32 s71, v39
    s_nop 0
    s_cmp_gt_u32 s71, 22
    s_cbranch_scc1 L_ck_57
    s_cmp_eq_u32 s83, 0
    s_cbranch_scc1 L_ck_57
    s_sub_u32 s83, s83, 1
    s_sleep 1
    s_branch L_cs_58
L_ck_57:
    ds_read_b128 v[128:131], v2 offset:49152
    s_cmp_gt_u32 s71, 23
    s_cbranch_scc1 L_ck_59
L_cs_60:
    ds_read_b32 v39, v26 offset:25856
    s_waitcnt lgkmcnt(0)
    v_readfirstlane_b32 s71, v39
    s_nop 0
    s_cmp_gt_u32 s71, 23
    s_cbranch_scc1 L_ck_59
    s_cmp_eq_u32 s83, 0
    s_cbranch_scc1 L_ck_59
    s_sub_u32 s83, s83, 1
    s_sleep 1
    s_branch L_cs_60
L_ck_59:
    ds_read_b128 v[132:135], v2 offset:57344
    v_mov_b32 v38, 24
    s_waitcnt lgkmcnt(0)
    s_mov_b64 exec, 1
    ds_write_b32 v27, v38 offset:25600
    s_mov_b64 exec, -1
    s_cmp_gt_u32 s71, 24
    s_cbranch_scc1 L_ck_61
L_cs_62:
    ds_read_b32 v39, v26 offset:25856
    s_waitcnt lgkmcnt(0)
    v_readfirstlane_b32 s71, v39
    s_nop 0
    s_cmp_gt_u32 s71, 24
    s_cbranch_scc1 L_ck_61
    s_cmp_eq_u32 s83, 0
    s_cbranch_scc1 L_ck_61
    s_sub_u32 s83, s83, 1
    s_sleep 1
    s_branch L_cs_62
L_ck_61:
    ds_read_b128 v[136:139], v0 offset:0
    s_cmp_gt_u32 s71, 25
    s_cbranch_scc1 L_ck_63
L_cs_64:
    ds_read_b32 v39, v26 offset:25856
    s_waitcnt lgkmcnt(0)
    v_readfirstlane_b32 s71, v39
    s_nop 0
    s_cmp_gt_u32 s71, 25
    s_cbranch_scc1 L_ck_63
    s_cmp_eq_u32 s83, 0
    s_cbranch_scc1 L_ck_63
    s_sub_u32 s83, s83, 1
    s_sleep 1
    s_branch L_cs_64
L_ck_63:
    ds_read_b128 v[140:143], v0 offset:8192
    v_mov_b32 v38, 26
    s_waitcnt lgkmcnt(0)
    s_mov_b64 exec, 1
    ds_write_b32 v27, v38 offset:25600
    s_mov_b64 exec, -1
    s_cmp_gt_u32 s71, 26
    s_cbranch_scc1 L_ck_65
L_cs_66:
    ds_read_b32 v39, v26 offset:25856
    s_waitcnt lgkmcnt(0)
    v_readfirstlane_b32 s71, v39
    s_nop 0
    s_cmp_gt_u32 s71, 26
    s_cbranch_scc1 L_ck_65
    s_cmp_eq_u32 s83, 0
    s_cbranch_scc1 L_ck_65
    s_sub_u32 s83, s83, 1
    s_sleep 1
    s_branch L_cs_66
L_ck_65:
    ds_read_b128 v[144:147], v0 offset:16384
    s_cmp_gt_u32 s71, 27
    s_cbranch_scc1 L_ck_67
L_cs_68:
    ds_read_b32 v39, v26 offset:25856
    s_waitcnt lgkmcnt(0)
    v_readfirstlane_b32 s71, v39
    s_nop 0
    s_cmp_gt_u32 s71, 27
    s_cbranch_scc1 L_ck_67
    s_cmp_eq_u32 s83, 0
    s_cbranch_scc1 L_ck_67
    s_sub_u32 s83, s83, 1
    s_sleep 1
    s_branch L_cs_68
L_ck_67:
    ds_read_b128 v[148:151], v0 offset:24576
    v_mov_b32 v38, 28
    s_waitcnt lgkmcnt(0)
    s_mov_b64 exec, 1
    ds_write_b32 v27, v38 offset:25600
    s_mov_b64 exec, -1
    s_cmp_gt_u32 s71, 28
    s_cbranch_scc1 L_ck_69
L_cs_70:
    ds_read_b32 v39, v26 offset:25856
    s_waitcnt lgkmcnt(0)
    v_readfirstlane_b32 s71, v39
    s_nop 0
    s_cmp_gt_u32 s71, 28
    s_cbranch_scc1 L_ck_69
    s_cmp_eq_u32 s83, 0
    s_cbranch_scc1 L_ck_69
    s_sub_u32 s83, s83, 1
    s_sleep 1
    s_branch L_cs_70
L_ck_69:
    ds_read_b128 v[152:155], v0 offset:32768
    s_cmp_gt_u32 s71, 29
    s_cbranch_scc1 L_ck_71
L_cs_72:
    ds_read_b32 v39, v26 offset:25856
    s_waitcnt lgkmcnt(0)
    v_readfirstlane_b32 s71, v39
    s_nop 0
    s_cmp_gt_u32 s71, 29
    s_cbranch_scc1 L_ck_71
    s_cmp_eq_u32 s83, 0
    s_cbranch_scc1 L_ck_71
    s_sub_u32 s83, s83, 1
    s_sleep 1
    s_branch L_cs_72
L_ck_71:
    ds_read_b128 v[156:159], v0 offset:40960
    v_mov_b32 v38, 30
    s_waitcnt lgkmcnt(0)
    s_mov_b64 exec, 1
    ds_write_b32 v27, v38 offset:25600
    s_mov_b64 exec, -1
    s_cmp_gt_u32 s71, 30
    s_cbranch_scc1 L_ck_73
L_cs_74:
    ds_read_b32 v39, v26 offset:25856
    s_waitcnt lgkmcnt(0)
    v_readfirstlane_b32 s71, v39
    s_nop 0
    s_cmp_gt_u32 s71, 30
    s_cbranch_scc1 L_ck_73
    s_cmp_eq_u32 s83, 0
    s_cbranch_scc1 L_ck_73
    s_sub_u32 s83, s83, 1
    s_sleep 1
    s_branch L_cs_74
L_ck_73:
    ds_read_b128 v[160:163], v0 offset:49152
    s_cmp_gt_u32 s71, 31
    s_cbranch_scc1 L_ck_75
L_cs_76:
    ds_read_b32 v39, v26 offset:25856
    s_waitcnt lgkmcnt(0)
    v_readfirstlane_b32 s71, v39
    s_nop 0
    s_cmp_gt_u32 s71, 31
    s_cbranch_scc1 L_ck_75
    s_cmp_eq_u32 s83, 0
    s_cbranch_scc1 L_ck_75
    s_sub_u32 s83, s83, 1
    s_sleep 1
    s_branch L_cs_76
L_ck_75:
    ds_read_b128 v[164:167], v0 offset:57344
    v_mov_b32 v38, 32
    s_waitcnt lgkmcnt(0)
    s_mov_b64 exec, 1
    ds_write_b32 v27, v38 offset:25600
    s_mov_b64 exec, -1
    s_waitcnt vmcnt(0)
    v_mov_b32 v28, 108
L_rdy:
    ds_read_b32 v29, v28
    ds_read_b128 v[8:11], v3 offset:128
    ds_read_b32 v30, v28 offset:12
    s_waitcnt lgkmcnt(0)
    v_cmp_eq_u32 vcc, 1, v29
    s_cbranch_vccnz L_rdyd
    s_cmp_eq_u32 s83, 0
    s_cbranch_scc1 L_rdyd
    s_sub_u32 s83, s83, 1
    s_sleep 1
    s_branch L_rdy
L_rdyd:
    v_readfirstlane_b32 s31, v30
    v_dot2_f32_bf16 v40, v40, v8, 0
    v_dot2_f32_bf16 v44, v44, v8, 0
    v_dot2_f32_bf16 v48, v48, v8, 0
    v_dot2_f32_bf16 v52, v52, v8, 0
    v_dot2_f32_bf16 v56, v56, v8, 0
    v_dot2_f32_bf16 v60, v60, v8, 0
    v_dot2_f32_bf16 v64, v64, v8, 0
    v_dot2_f32_bf16 v68, v68, v8, 0
    v_dot2_f32_bf16 v40, v41, v9, v40
    v_dot2_f32_bf16 v44, v45, v9, v44
    v_dot2_f32_bf16 v48, v49, v9, v48
    v_dot2_f32_bf16 v52, v53, v9, v52
    v_dot2_f32_bf16 v56, v57, v9, v56
    v_dot2_f32_bf16 v60, v61, v9, v60
    v_dot2_f32_bf16 v64, v65, v9, v64
    v_dot2_f32_bf16 v68, v69, v9, v68
    v_dot2_f32_bf16 v40, v42, v10, v40
    v_dot2_f32_bf16 v44, v46, v10, v44
    v_dot2_f32_bf16 v48, v50, v10, v48
    v_dot2_f32_bf16 v52, v54, v10, v52
    v_dot2_f32_bf16 v56, v58, v10, v56
    v_dot2_f32_bf16 v60, v62, v10, v60
    v_dot2_f32_bf16 v64, v66, v10, v64
    v_dot2_f32_bf16 v68, v70, v10, v68
    v_dot2_f32_bf16 v40, v43, v11, v40
    v_dot2_f32_bf16 v44, v47, v11, v44
    v_dot2_f32_bf16 v48, v51, v11, v48
    v_dot2_f32_bf16 v52, v55, v11, v52
    v_dot2_f32_bf16 v56, v59, v11, v56
    v_dot2_f32_bf16 v60, v63, v11, v60
    v_dot2_f32_bf16 v64, v67, v11, v64
    v_dot2_f32_bf16 v68, v71, v11, v68
    v_dot2_f32_bf16 v72, v72, v8, 0
    v_dot2_f32_bf16 v76, v76, v8, 0
    v_dot2_f32_bf16 v80, v80, v8, 0
    v_dot2_f32_bf16 v84, v84, v8, 0
    v_dot2_f32_bf16 v88, v88, v8, 0
    v_dot2_f32_bf16 v92, v92, v8, 0
    v_dot2_f32_bf16 v96, v96, v8, 0
    v_dot2_f32_bf16 v100, v100, v8, 0
    v_dot2_f32_bf16 v72, v73, v9, v72
    v_dot2_f32_bf16 v76, v77, v9, v76
    v_dot2_f32_bf16 v80, v81, v9, v80
    v_dot2_f32_bf16 v84, v85, v9, v84
    v_dot2_f32_bf16 v88, v89, v9, v88
    v_dot2_f32_bf16 v92, v93, v9, v92
    v_dot2_f32_bf16 v96, v97, v9, v96
    v_dot2_f32_bf16 v100, v101, v9, v100
    v_dot2_f32_bf16 v72, v74, v10, v72
    v_dot2_f32_bf16 v76, v78, v10, v76
    v_dot2_f32_bf16 v80, v82, v10, v80
    v_dot2_f32_bf16 v84, v86, v10, v84
    v_dot2_f32_bf16 v88, v90, v10, v88
    v_dot2_f32_bf16 v92, v94, v10, v92
    v_dot2_f32_bf16 v96, v98, v10, v96
    v_dot2_f32_bf16 v100, v102, v10, v100
    v_dot2_f32_bf16 v72, v75, v11, v72
    v_dot2_f32_bf16 v76, v79, v11, v76
    v_dot2_f32_bf16 v80, v83, v11, v80
    v_dot2_f32_bf16 v84, v87, v11, v84
    v_dot2_f32_bf16 v88, v91, v11, v88
    v_dot2_f32_bf16 v92, v95, v11, v92
    v_dot2_f32_bf16 v96, v99, v11, v96
    v_dot2_f32_bf16 v100, v103, v11, v100
    v_dot2_f32_bf16 v104, v104, v8, 0
    v_dot2_f32_bf16 v108, v108, v8, 0
    v_dot2_f32_bf16 v112, v112, v8, 0
    v_dot2_f32_bf16 v116, v116, v8, 0
    v_dot2_f32_bf16 v120, v120, v8, 0
    v_dot2_f32_bf16 v124, v124, v8, 0
    v_dot2_f32_bf16 v128, v128, v8, 0
    v_dot2_f32_bf16 v132, v132, v8, 0
    v_dot2_f32_bf16 v104, v105, v9, v104
    v_dot2_f32_bf16 v108, v109, v9, v108
    v_dot2_f32_bf16 v112, v113, v9, v112
    v_dot2_f32_bf16 v116, v117, v9, v116
    v_dot2_f32_bf16 v120, v121, v9, v120
    v_dot2_f32_bf16 v124, v125, v9, v124
    v_dot2_f32_bf16 v128, v129, v9, v128
    v_dot2_f32_bf16 v132, v133, v9, v132
    v_dot2_f32_bf16 v104, v106, v10, v104
    v_dot2_f32_bf16 v108, v110, v10, v108
    v_dot2_f32_bf16 v112, v114, v10, v112
    v_dot2_f32_bf16 v116, v118, v10, v116
    v_dot2_f32_bf16 v120, v122, v10, v120
    v_dot2_f32_bf16 v124, v126, v10, v124
    v_dot2_f32_bf16 v128, v130, v10, v128
    v_dot2_f32_bf16 v132, v134, v10, v132
    v_dot2_f32_bf16 v104, v107, v11, v104
    v_dot2_f32_bf16 v108, v111, v11, v108
    v_dot2_f32_bf16 v112, v115, v11, v112
    v_dot2_f32_bf16 v116, v119, v11, v116
    v_dot2_f32_bf16 v120, v123, v11, v120
    v_dot2_f32_bf16 v124, v127, v11, v124
    v_dot2_f32_bf16 v128, v131, v11, v128
    v_dot2_f32_bf16 v132, v135, v11, v132
    v_dot2_f32_bf16 v136, v136, v8, 0
    v_dot2_f32_bf16 v140, v140, v8, 0
    v_dot2_f32_bf16 v144, v144, v8, 0
    v_dot2_f32_bf16 v148, v148, v8, 0
    v_dot2_f32_bf16 v152, v152, v8, 0
    v_dot2_f32_bf16 v156, v156, v8, 0
    v_dot2_f32_bf16 v160, v160, v8, 0
    v_dot2_f32_bf16 v164, v164, v8, 0
    v_dot2_f32_bf16 v136, v137, v9, v136
    v_dot2_f32_bf16 v140, v141, v9, v140
    v_dot2_f32_bf16 v144, v145, v9, v144
    v_dot2_f32_bf16 v148, v149, v9, v148
    v_dot2_f32_bf16 v152, v153, v9, v152
    v_dot2_f32_bf16 v156, v157, v9, v156
    v_dot2_f32_bf16 v160, v161, v9, v160
    v_dot2_f32_bf16 v164, v165, v9, v164
    v_dot2_f32_bf16 v136, v138, v10, v136
    v_dot2_f32_bf16 v140, v142, v10, v140
    v_dot2_f32_bf16 v144, v146, v10, v144
    v_dot2_f32_bf16 v148, v150, v10, v148
    v_dot2_f32_bf16 v152, v154, v10, v152
    v_dot2_f32_bf16 v156, v158, v10, v156
    v_dot2_f32_bf16 v160, v162, v10, v160
    v_dot2_f32_bf16 v164, v166, v10, v164
    v_dot2_f32_bf16 v136, v139, v11, v136
    v_dot2_f32_bf16 v140, v143, v11, v140
    v_dot2_f32_bf16 v144, v147, v11, v144
    v_dot2_f32_bf16 v148, v151, v11, v148
    v_dot2_f32_bf16 v152, v155, v11, v152
    v_dot2_f32_bf16 v156, v159, v11, v156
    v_dot2_f32_bf16 v160, v163, v11, v160
    v_dot2_f32_bf16 v164, v167, v11, v164
    v_permlane16_swap_b32 v40, v44
    v_permlane16_swap_b32 v48, v52
    v_permlane16_swap_b32 v56, v60
    v_permlane16_swap_b32 v64, v68
    v_permlane16_swap_b32 v72, v76
    v_permlane16_swap_b32 v80, v84
    v_permlane16_swap_b32 v88, v92
    v_permlane16_swap_b32 v96, v100
    v_permlane16_swap_b32 v104, v108
    v_permlane16_swap_b32 v112, v116
    v_permlane16_swap_b32 v120, v124
    v_permlane16_swap_b32 v128, v132
    v_permlane16_swap_b32 v136, v140
    v_permlane16_swap_b32 v144, v148
    v_permlane16_swap_b32 v152, v156
    v_permlane16_swap_b32 v160, v164
    v_add_f32 v40, v40, v44
    v_add_f32 v48, v48, v52
    v_add_f32 v56, v56, v60
    v_add_f32 v64, v64, v68
    v_add_f32 v72, v72, v76
    v_add_f32 v80, v80, v84
    v_add_f32 v88, v88, v92
    v_add_f32 v96, v96, v100
    v_add_f32 v104, v104, v108
    v_add_f32 v112, v112, v116
    v_add_f32 v120, v120, v124
    v_add_f32 v128, v128, v132
    v_add_f32 v136, v136, v140
    v_add_f32 v144, v144, v148
    v_add_f32 v152, v152, v156
    v_add_f32 v160, v160, v164
    v_add_f32_dpp v40, v40, v40 row_ror:8 row_mask:0xf bank_mask:3
    v_add_f32_dpp v56, v56, v56 row_ror:8 row_mask:0xf bank_mask:3
    v_add_f32_dpp v72, v72, v72 row_ror:8 row_mask:0xf bank_mask:3
    v_add_f32_dpp v88, v88, v88 row_ror:8 row_mask:0xf bank_mask:3
    v_add_f32_dpp v104, v104, v104 row_ror:8 row_mask:0xf bank_mask:3
    v_add_f32_dpp v120, v120, v120 row_ror:8 row_mask:0xf bank_mask:3
    v_add_f32_dpp v136, v136, v136 row_ror:8 row_mask:0xf bank_mask:3
    v_add_f32_dpp v152, v152, v152 row_ror:8 row_mask:0xf bank_mask:3
    v_add_f32_dpp v40, v48, v48 row_ror:8 row_mask:0xf bank_mask:12
    v_add_f32_dpp v56, v64, v64 row_ror:8 row_mask:0xf bank_mask:12
    v_add_f32_dpp v72, v80, v80 row_ror:8 row_mask:0xf bank_mask:12
    v_add_f32_dpp v88, v96, v96 row_ror:8 row_mask:0xf bank_mask:12
    v_add_f32_dpp v104, v112, v112 row_ror:8 row_mask:0xf bank_mask:12
    v_add_f32_dpp v120, v128, v128 row_ror:8 row_mask:0xf bank_mask:12
    v_add_f32_dpp v136, v144, v144 row_ror:8 row_mask:0xf bank_mask:12
    v_add_f32_dpp v152, v160, v160 row_ror:8 row_mask:0xf bank_mask:12
    v_add_f32_dpp v40, v40, v40 row_half_mirror row_mask:0xf bank_mask:5
    v_add_f32_dpp v72, v72, v72 row_half_mirror row_mask:0xf bank_mask:5
    v_add_f32_dpp v104, v104, v104 row_half_mirror row_mask:0xf bank_mask:5
    v_add_f32_dpp v136, v136, v136 row_half_mirror row_mask:0xf bank_mask:5
    v_add_f32_dpp v40, v56, v56 row_half_mirror row_mask:0xf bank_mask:10
    v_add_f32_dpp v72, v88, v88 row_half_mirror row_mask:0xf bank_mask:10
    v_add_f32_dpp v104, v120, v120 row_half_mirror row_mask:0xf bank_mask:10
    v_add_f32_dpp v136, v152, v152 row_half_mirror row_mask:0xf bank_mask:10
    v_add_f32_dpp v40, v40, v40 quad_perm:[2,3,0,1] row_mask:0xf bank_mask:0xf
    v_add_f32_dpp v72, v72, v72 quad_perm:[2,3,0,1] row_mask:0xf bank_mask:0xf
    v_add_f32_dpp v104, v104, v104 quad_perm:[2,3,0,1] row_mask:0xf bank_mask:0xf
    v_add_f32_dpp v136, v136, v136 quad_perm:[2,3,0,1] row_mask:0xf bank_mask:0xf
    v_cndmask_b32 v40, v40, v72, s[78:79]
    v_cndmask_b32 v104, v104, v136, s[78:79]
    s_nop 0
    v_add_f32_dpp v40, v40, v40 quad_perm:[1,0,3,2] row_mask:0xf bank_mask:0xf
    v_add_f32_dpp v104, v104, v104 quad_perm:[1,0,3,2] row_mask:0xf bank_mask:0xf
    v_cndmask_b32 v40, v40, v104, s[80:81]
    v_cvt_pk_bf16_f32 v36, 0, v40
    v_mov_b32 v28, v36
    s_nop 1
    v_max_f32_dpp v28, v28, v28 quad_perm:[1,0,3,2] row_mask:0xf bank_mask:0xf
    s_nop 1
    v_max_f32_dpp v28, v28, v28 quad_perm:[2,3,0,1] row_mask:0xf bank_mask:0xf
    s_nop 1
    v_max_f32_dpp v28, v28, v28 row_half_mirror row_mask:0xf bank_mask:0xf
    s_nop 1
    v_max_f32_dpp v28, v28, v28 row_ror:8 row_mask:0xf bank_mask:0xf
    v_mov_b32 v29, v28
    s_nop 1
    v_permlane16_swap_b32 v28, v29
    v_max_f32 v28, v28, v29
    v_mov_b32 v29, v28
    s_nop 1
    v_permlane32_swap_b32 v28, v29
    v_max_f32 v28, v28, v29
    v_sub_f32 v36, v36, v28
    v_mul_f32 v36, 0x3db8aa3b, v36
    v_exp_f32 v36, v36
    s_nop 0
    v_mov_b32 v29, v36
    s_nop 1
    v_add_f32_dpp v29, v29, v29 quad_perm:[1,0,3,2] row_mask:0xf bank_mask:0xf
    s_nop 1
    v_add_f32_dpp v29, v29, v29 quad_perm:[2,3,0,1] row_mask:0xf bank_mask:0xf
    s_nop 1
    v_add_f32_dpp v29, v29, v29 row_half_mirror row_mask:0xf bank_mask:0xf
    s_nop 1
    v_add_f32_dpp v29, v29, v29 row_ror:8 row_mask:0xf bank_mask:0xf
    v_mov_b32 v30, v29
    s_nop 1
    v_permlane16_swap_b32 v29, v30
    v_add_f32 v29, v29, v30
    v_mov_b32 v30, v29
    s_nop 1
    v_permlane32_swap_b32 v29, v30
    v_add_f32 v29, v29, v30
    s_lshl_b32 s76, s75, 3
    v_mov_b32 v30, s76
    ds_write_b64 v30, v[28:29] offset:0
    v_cvt_pk_bf16_f32 v20, v36, 0
    v_cvt_pk_bf16_f32 v21, 0, v36
    v_mov_b32 v22, v20
    v_mov_b32 v23, v21
    s_nop 0
    v_permlane16_swap_b32 v20, v22
    v_permlane16_swap_b32 v21, v23
    v_mov_b32 v30, 100
    v_mov_b32 v31, 1
    s_waitcnt lgkmcnt(0)
    s_mov_b64 exec, 1
    ds_add_rtn_u32 v31, v30, v31
    s_mov_b64 exec, -1
    s_waitcnt lgkmcnt(0)
    v_readfirstlane_b32 s76, v31
    s_nop 0
    s_cmp_lg_u32 s76, 7
    s_cbranch_scc1 L_noml
    v_and_b32 v30, 7, v1
    v_lshlrev_b32 v31, 3, v30
    ds_read_b64 v[32:33], v31 offset:0
    v_lshlrev_b32 v31, 2, v30
    v_mov_b32 v30, s70
    s_waitcnt lgkmcnt(0)
    v_mov_b32 v8, v32
    s_nop 1
    v_max_f32_dpp v8, v8, v8 quad_perm:[1,0,3,2] row_mask:0xf bank_mask:0xf
    s_nop 1
    v_max_f32_dpp v8, v8, v8 quad_perm:[2,3,0,1] row_mask:0xf bank_mask:0xf
    s_nop 1
    v_max_f32_dpp v8, v8, v8 row_half_mirror row_mask:0xf bank_mask:0xf
    v_sub_f32 v32, v32, v8
    v_mul_f32 v32, 0x3db8aa3b, v32
    v_exp_f32 v32, v32
    s_nop 0
    v_mul_f32 v9, v32, v33
    ds_write_b32 v31, v32 offset:64
    v_mov_b32 v31, 112
    v_mov_b32 v35, 1
    s_waitcnt lgkmcnt(0)
    ds_write_b32 v31, v35
    v_add_f32_dpp v9, v9, v9 quad_perm:[1,0,3,2] row_mask:0xf bank_mask:0xf
    s_nop 1
    v_add_f32_dpp v9, v9, v9 quad_perm:[2,3,0,1] row_mask:0xf bank_mask:0xf
    s_nop 1
    v_add_f32_dpp v9, v9, v9 row_half_mirror row_mask:0xf bank_mask:0xf
    v_mov_b32 v10, s68
    v_mov_b32 v11, s69
    s_mov_b64 exec, 1
    v_add_u32 v30, 6144, v30
    buffer_store_dwordx4 v[8:11], v30, s[64:67], 0 offen
    v_mov_b32 v31, 25568
    ds_write_b128 v31, v[8:11]
    s_mov_b64 exec, -1
    s_nop 1
L_noml:
    v_mov_b32 v12, 0
    v_mov_b32 v13, 0
    v_mov_b32 v14, 0
    v_mov_b32 v15, 0
    v_mov_b32 v16, 0
    v_mov_b32 v17, 0
    v_mov_b32 v18, 0
    v_mov_b32 v19, 0
    s_cmp_gt_u32 s71, 32
    s_cbranch_scc1 L_ck_77
L_cs_78:
    ds_read_b32 v39, v26 offset:25856
    s_waitcnt lgkmcnt(0)
    v_readfirstlane_b32 s71, v39
    s_nop 0
    s_cmp_gt_u32 s71, 32
    s_cbranch_scc1 L_ck_77
    s_cmp_eq_u32 s83, 0
    s_cbranch_scc1 L_ck_77
    s_sub_u32 s83, s83, 1
    s_sleep 1
    s_branch L_cs_78
L_ck_77:
    ds_read_b128 v[44:47], v2 offset:0
    s_cmp_eq_u32 s74, 7
    s_cbranch_scc1 L_nw_79
    buffer_load_dwordx4 v[60:63], v6, s[44:47], 0 offen offset:0 nt
L_nw_79:
    s_waitcnt lgkmcnt(0)
    s_cmp_gt_u32 s71, 33
    s_cbranch_scc1 L_ck_80
L_cs_81:
    ds_read_b32 v39, v26 offset:25856
    s_waitcnt lgkmcnt(0)
    v_readfirstlane_b32 s71, v39
    s_nop 0
    s_cmp_gt_u32 s71, 33
    s_cbranch_scc1 L_ck_80
    s_cmp_eq_u32 s83, 0
    s_cbranch_scc1 L_ck_80
    s_sub_u32 s83, s83, 1
    s_sleep 1
    s_branch L_cs_81
L_ck_80:
    ds_read_b128 v[48:51], v2 offset:8192
    v_dot2c_f32_bf16_dpp v12, v20, v44 row_newbcast:0 row_mask:0xf bank_mask:0xf
    v_dot2c_f32_bf16_dpp v13, v21, v44 row_newbcast:0 row_mask:0xf bank_mask:0xf
    v_dot2c_f32_bf16_dpp v14, v20, v45 row_newbcast:0 row_mask:0xf bank_mask:0xf
    v_dot2c_f32_bf16_dpp v15, v21, v45 row_newbcast:0 row_mask:0xf bank_mask:0xf
    v_dot2c_f32_bf16_dpp v16, v20, v46 row_newbcast:0 row_mask:0xf bank_mask:0xf
    v_dot2c_f32_bf16_dpp v17, v21, v46 row_newbcast:0 row_mask:0xf bank_mask:0xf
    v_dot2c_f32_bf16_dpp v18, v20, v47 row_newbcast:0 row_mask:0xf bank_mask:0xf
    v_dot2c_f32_bf16_dpp v19, v21, v47 row_newbcast:0 row_mask:0xf bank_mask:0xf
    s_cmp_eq_u32 s74, 7
    s_cbranch_scc1 L_nw_82
    buffer_load_dwordx4 v[64:67], v6, s[44:47], 0 offen offset:896 nt
L_nw_82:
    v_mov_b32 v38, 34
    s_waitcnt lgkmcnt(0)
    s_mov_b64 exec, 1
    ds_write_b32 v27, v38 offset:25600
    s_mov_b64 exec, -1
    s_cmp_gt_u32 s71, 34
    s_cbranch_scc1 L_ck_83
L_cs_84:
    ds_read_b32 v39, v26 offset:25856
    s_waitcnt lgkmcnt(0)
    v_readfirstlane_b32 s71, v39
    s_nop 0
    s_cmp_gt_u32 s71, 34
    s_cbranch_scc1 L_ck_83
    s_cmp_eq_u32 s83, 0
    s_cbranch_scc1 L_ck_83
    s_sub_u32 s83, s83, 1
    s_sleep 1
    s_branch L_cs_84
L_ck_83:
    ds_read_b128 v[52:55], v2 offset:16384
    v_dot2c_f32_bf16_dpp v12, v22, v48 row_newbcast:0 row_mask:0xf bank_mask:0xf
    v_dot2c_f32_bf16_dpp v13, v23, v48 row_newbcast:0 row_mask:0xf bank_mask:0xf
    v_dot2c_f32_bf16_dpp v14, v22, v49 row_newbcast:0 row_mask:0xf bank_mask:0xf
    v_dot2c_f32_bf16_dpp v15, v23, v49 row_newbcast:0 row_mask:0xf bank_mask:0xf
    v_dot2c_f32_bf16_dpp v16, v22, v50 row_newbcast:0 row_mask:0xf bank_mask:0xf
    v_dot2c_f32_bf16_dpp v17, v23, v50 row_newbcast:0 row_mask:0xf bank_mask:0xf
    v_dot2c_f32_bf16_dpp v18, v22, v51 row_newbcast:0 row_mask:0xf bank_mask:0xf
    v_dot2c_f32_bf16_dpp v19, v23, v51 row_newbcast:0 row_mask:0xf bank_mask:0xf
    s_cmp_eq_u32 s74, 7
    s_cbranch_scc1 L_nw_85
    buffer_load_dwordx4 v[68:71], v6, s[44:47], 0 offen offset:1792 nt
L_nw_85:
    s_waitcnt lgkmcnt(0)
    s_cmp_gt_u32 s71, 35
    s_cbranch_scc1 L_ck_86
L_cs_87:
    ds_read_b32 v39, v26 offset:25856
    s_waitcnt lgkmcnt(0)
    v_readfirstlane_b32 s71, v39
    s_nop 0
    s_cmp_gt_u32 s71, 35
    s_cbranch_scc1 L_ck_86
    s_cmp_eq_u32 s83, 0
    s_cbranch_scc1 L_ck_86
    s_sub_u32 s83, s83, 1
    s_sleep 1
    s_branch L_cs_87
L_ck_86:
    ds_read_b128 v[56:59], v2 offset:24576
    v_dot2c_f32_bf16_dpp v12, v20, v52 row_newbcast:8 row_mask:0xf bank_mask:0xf
    v_dot2c_f32_bf16_dpp v13, v21, v52 row_newbcast:8 row_mask:0xf bank_mask:0xf
    v_dot2c_f32_bf16_dpp v14, v20, v53 row_newbcast:8 row_mask:0xf bank_mask:0xf
    v_dot2c_f32_bf16_dpp v15, v21, v53 row_newbcast:8 row_mask:0xf bank_mask:0xf
    v_dot2c_f32_bf16_dpp v16, v20, v54 row_newbcast:8 row_mask:0xf bank_mask:0xf
    v_dot2c_f32_bf16_dpp v17, v21, v54 row_newbcast:8 row_mask:0xf bank_mask:0xf
    v_dot2c_f32_bf16_dpp v18, v20, v55 row_newbcast:8 row_mask:0xf bank_mask:0xf
    v_dot2c_f32_bf16_dpp v19, v21, v55 row_newbcast:8 row_mask:0xf bank_mask:0xf
    s_cmp_eq_u32 s74, 7
    s_cbranch_scc1 L_nw_88
    buffer_load_dwordx4 v[72:75], v6, s[44:47], 0 offen offset:2688 nt
L_nw_88:
    v_mov_b32 v38, 36
    s_waitcnt lgkmcnt(0)
    s_mov_b64 exec, 1
    ds_write_b32 v27, v38 offset:25600
    s_mov_b64 exec, -1
    s_cmp_gt_u32 s71, 36
    s_cbranch_scc1 L_ck_89
L_cs_90:
    ds_read_b32 v39, v26 offset:25856
    s_waitcnt lgkmcnt(0)
    v_readfirstlane_b32 s71, v39
    s_nop 0
    s_cmp_gt_u32 s71, 36
    s_cbranch_scc1 L_ck_89
    s_cmp_eq_u32 s83, 0
    s_cbranch_scc1 L_ck_89
    s_sub_u32 s83, s83, 1
    s_sleep 1
    s_branch L_cs_90
L_ck_89:
    ds_read_b128 v[44:47], v2 offset:32768
    v_dot2c_f32_bf16_dpp v12, v22, v56 row_newbcast:8 row_mask:0xf bank_mask:0xf
    v_dot2c_f32_bf16_dpp v13, v23, v56 row_newbcast:8 row_mask:0xf bank_mask:0xf
    v_dot2c_f32_bf16_dpp v14, v22, v57 row_newbcast:8 row_mask:0xf bank_mask:0xf
    v_dot2c_f32_bf16_dpp v15, v23, v57 row_newbcast:8 row_mask:0xf bank_mask:0xf
    v_dot2c_f32_bf16_dpp v16, v22, v58 row_newbcast:8 row_mask:0xf bank_mask:0xf
    v_dot2c_f32_bf16_dpp v17, v23, v58 row_newbcast:8 row_mask:0xf bank_mask:0xf
    v_dot2c_f32_bf16_dpp v18, v22, v59 row_newbcast:8 row_mask:0xf bank_mask:0xf
    v_dot2c_f32_bf16_dpp v19, v23, v59 row_newbcast:8 row_mask:0xf bank_mask:0xf
    s_cmp_eq_u32 s74, 7
    s_cbranch_scc1 L_nw_91
    s_cmp_gt_u32 s72, 13
    s_cbranch_scc1 L_nw_91
    buffer_load_dwordx4 v[76:79], v7, s[48:51], 0 offen offset:0 nt
L_nw_91:
    s_waitcnt lgkmcnt(0)
    s_cmp_gt_u32 s71, 37
    s_cbranch_scc1 L_ck_92
L_cs_93:
    ds_read_b32 v39, v26 offset:25856
    s_waitcnt lgkmcnt(0)
    v_readfirstlane_b32 s71, v39
    s_nop 0
    s_cmp_gt_u32 s71, 37
    s_cbranch_scc1 L_ck_92
    s_cmp_eq_u32 s83, 0
    s_cbranch_scc1 L_ck_92
    s_sub_u32 s83, s83, 1
    s_sleep 1
    s_branch L_cs_93
L_ck_92:
    ds_read_b128 v[48:51], v2 offset:40960
    v_dot2c_f32_bf16_dpp v12, v20, v44 row_newbcast:4 row_mask:0xf bank_mask:0xf
    v_dot2c_f32_bf16_dpp v13, v21, v44 row_newbcast:4 row_mask:0xf bank_mask:0xf
    v_dot2c_f32_bf16_dpp v14, v20, v45 row_newbcast:4 row_mask:0xf bank_mask:0xf
    v_dot2c_f32_bf16_dpp v15, v21, v45 row_newbcast:4 row_mask:0xf bank_mask:0xf
    v_dot2c_f32_bf16_dpp v16, v20, v46 row_newbcast:4 row_mask:0xf bank_mask:0xf
    v_dot2c_f32_bf16_dpp v17, v21, v46 row_newbcast:4 row_mask:0xf bank_mask:0xf
    v_dot2c_f32_bf16_dpp v18, v20, v47 row_newbcast:4 row_mask:0xf bank_mask:0xf
    v_dot2c_f32_bf16_dpp v19, v21, v47 row_newbcast:4 row_mask:0xf bank_mask:0xf
    s_cmp_eq_u32 s74, 7
    s_cbranch_scc1 L_nw_94
    s_cmp_gt_u32 s72, 13
    s_cbranch_scc1 L_nw_94
    buffer_load_dwordx4 v[80:83], v7, s[48:51], 0 offen offset:896 nt
L_nw_94:
    v_mov_b32 v38, 38
    s_waitcnt lgkmcnt(0)
    s_mov_b64 exec, 1
    ds_write_b32 v27, v38 offset:25600
    s_mov_b64 exec, -1
    s_cmp_gt_u32 s71, 38
    s_cbranch_scc1 L_ck_95
L_cs_96:
    ds_read_b32 v39, v26 offset:25856
    s_waitcnt lgkmcnt(0)
    v_readfirstlane_b32 s71, v39
    s_nop 0
    s_cmp_gt_u32 s71, 38
    s_cbranch_scc1 L_ck_95
    s_cmp_eq_u32 s83, 0
    s_cbranch_scc1 L_ck_95
    s_sub_u32 s83, s83, 1
    s_sleep 1
    s_branch L_cs_96
L_ck_95:
    ds_read_b128 v[52:55], v2 offset:49152
    v_dot2c_f32_bf16_dpp v12, v22, v48 row_newbcast:4 row_mask:0xf bank_mask:0xf
    v_dot2c_f32_bf16_dpp v13, v23, v48 row_newbcast:4 row_mask:0xf bank_mask:0xf
    v_dot2c_f32_bf16_dpp v14, v22, v49 row_newbcast:4 row_mask:0xf bank_mask:0xf
    v_dot2c_f32_bf16_dpp v15, v23, v49 row_newbcast:4 row_mask:0xf bank_mask:0xf
    v_dot2c_f32_bf16_dpp v16, v22, v50 row_newbcast:4 row_mask:0xf bank_mask:0xf
    v_dot2c_f32_bf16_dpp v17, v23, v50 row_newbcast:4 row_mask:0xf bank_mask:0xf
    v_dot2c_f32_bf16_dpp v18, v22, v51 row_newbcast:4 row_mask:0xf bank_mask:0xf
    v_dot2c_f32_bf16_dpp v19, v23, v51 row_newbcast:4 row_mask:0xf bank_mask:0xf
    s_waitcnt lgkmcnt(0)
    s_cmp_gt_u32 s71, 39
    s_cbranch_scc1 L_ck_97
L_cs_98:
    ds_read_b32 v39, v26 offset:25856
    s_waitcnt lgkmcnt(0)
    v_readfirstlane_b32 s71, v39
    s_nop 0
    s_cmp_gt_u32 s71, 39
    s_cbranch_scc1 L_ck_97
    s_cmp_eq_u32 s83, 0
    s_cbranch_scc1 L_ck_97
    s_sub_u32 s83, s83, 1
    s_sleep 1
    s_branch L_cs_98
L_ck_97:
    ds_read_b128 v[56:59], v2 offset:57344
    v_dot2c_f32_bf16_dpp v12, v20, v52 row_newbcast:12 row_mask:0xf bank_mask:0xf
    v_dot2c_f32_bf16_dpp v13, v21, v52 row_newbcast:12 row_mask:0xf bank_mask:0xf
    v_dot2c_f32_bf16_dpp v14, v20, v53 row_newbcast:12 row_mask:0xf bank_mask:0xf
    v_dot2c_f32_bf16_dpp v15, v21, v53 row_newbcast:12 row_mask:0xf bank_mask:0xf
    v_dot2c_f32_bf16_dpp v16, v20, v54 row_newbcast:12 row_mask:0xf bank_mask:0xf
    v_dot2c_f32_bf16_dpp v17, v21, v54 row_newbcast:12 row_mask:0xf bank_mask:0xf
    v_dot2c_f32_bf16_dpp v18, v20, v55 row_newbcast:12 row_mask:0xf bank_mask:0xf
    v_dot2c_f32_bf16_dpp v19, v21, v55 row_newbcast:12 row_mask:0xf bank_mask:0xf
    v_mov_b32 v38, 40
    s_waitcnt lgkmcnt(0)
    s_mov_b64 exec, 1
    ds_write_b32 v27, v38 offset:25600
    s_mov_b64 exec, -1
    s_cmp_gt_u32 s71, 40
    s_cbranch_scc1 L_ck_99
L_cs_100:
    ds_read_b32 v39, v26 offset:25856
    s_waitcnt lgkmcnt(0)
    v_readfirstlane_b32 s71, v39
    s_nop 0
    s_cmp_gt_u32 s71, 40
    s_cbranch_scc1 L_ck_99
    s_cmp_eq_u32 s83, 0
    s_cbranch_scc1 L_ck_99
    s_sub_u32 s83, s83, 1
    s_sleep 1
    s_branch L_cs_100
L_ck_99:
    ds_read_b128 v[44:47], v0 offset:0
    v_dot2c_f32_bf16_dpp v12, v22, v56 row_newbcast:12 row_mask:0xf bank_mask:0xf
    v_dot2c_f32_bf16_dpp v13, v23, v56 row_newbcast:12 row_mask:0xf bank_mask:0xf
    v_dot2c_f32_bf16_dpp v14, v22, v57 row_newbcast:12 row_mask:0xf bank_mask:0xf
    v_dot2c_f32_bf16_dpp v15, v23, v57 row_newbcast:12 row_mask:0xf bank_mask:0xf
    v_dot2c_f32_bf16_dpp v16, v22, v58 row_newbcast:12 row_mask:0xf bank_mask:0xf
    v_dot2c_f32_bf16_dpp v17, v23, v58 row_newbcast:12 row_mask:0xf bank_mask:0xf
    v_dot2c_f32_bf16_dpp v18, v22, v59 row_newbcast:12 row_mask:0xf bank_mask:0xf
    v_dot2c_f32_bf16_dpp v19, v23, v59 row_newbcast:12 row_mask:0xf bank_mask:0xf
    s_waitcnt lgkmcnt(0)
    s_cmp_gt_u32 s71, 41
    s_cbranch_scc1 L_ck_101
L_cs_102:
    ds_read_b32 v39, v26 offset:25856
    s_waitcnt lgkmcnt(0)
    v_readfirstlane_b32 s71, v39
    s_nop 0
    s_cmp_gt_u32 s71, 41
    s_cbranch_scc1 L_ck_101
    s_cmp_eq_u32 s83, 0
    s_cbranch_scc1 L_ck_101
    s_sub_u32 s83, s83, 1
    s_sleep 1
    s_branch L_cs_102
L_ck_101:
    ds_read_b128 v[48:51], v0 offset:8192
    v_dot2c_f32_bf16_dpp v12, v20, v44 row_newbcast:2 row_mask:0xf bank_mask:0xf
    v_dot2c_f32_bf16_dpp v13, v21, v44 row_newbcast:2 row_mask:0xf bank_mask:0xf
    v_dot2c_f32_bf16_dpp v14, v20, v45 row_newbcast:2 row_mask:0xf bank_mask:0xf
    v_dot2c_f32_bf16_dpp v15, v21, v45 row_newbcast:2 row_mask:0xf bank_mask:0xf
    v_dot2c_f32_bf16_dpp v16, v20, v46 row_newbcast:2 row_mask:0xf bank_mask:0xf
    v_dot2c_f32_bf16_dpp v17, v21, v46 row_newbcast:2 row_mask:0xf bank_mask:0xf
    v_dot2c_f32_bf16_dpp v18, v20, v47 row_newbcast:2 row_mask:0xf bank_mask:0xf
    v_dot2c_f32_bf16_dpp v19, v21, v47 row_newbcast:2 row_mask:0xf bank_mask:0xf
    v_mov_b32 v38, 42
    s_waitcnt lgkmcnt(0)
    s_mov_b64 exec, 1
    ds_write_b32 v27, v38 offset:25600
    s_mov_b64 exec, -1
    s_cmp_gt_u32 s71, 42
    s_cbranch_scc1 L_ck_103
L_cs_104:
    ds_read_b32 v39, v26 offset:25856
    s_waitcnt lgkmcnt(0)
    v_readfirstlane_b32 s71, v39
    s_nop 0
    s_cmp_gt_u32 s71, 42
    s_cbranch_scc1 L_ck_103
    s_cmp_eq_u32 s83, 0
    s_cbranch_scc1 L_ck_103
    s_sub_u32 s83, s83, 1
    s_sleep 1
    s_branch L_cs_104
L_ck_103:
    ds_read_b128 v[52:55], v0 offset:16384
    v_dot2c_f32_bf16_dpp v12, v22, v48 row_newbcast:2 row_mask:0xf bank_mask:0xf
    v_dot2c_f32_bf16_dpp v13, v23, v48 row_newbcast:2 row_mask:0xf bank_mask:0xf
    v_dot2c_f32_bf16_dpp v14, v22, v49 row_newbcast:2 row_mask:0xf bank_mask:0xf
    v_dot2c_f32_bf16_dpp v15, v23, v49 row_newbcast:2 row_mask:0xf bank_mask:0xf
    v_dot2c_f32_bf16_dpp v16, v22, v50 row_newbcast:2 row_mask:0xf bank_mask:0xf
    v_dot2c_f32_bf16_dpp v17, v23, v50 row_newbcast:2 row_mask:0xf bank_mask:0xf
    v_dot2c_f32_bf16_dpp v18, v22, v51 row_newbcast:2 row_mask:0xf bank_mask:0xf
    v_dot2c_f32_bf16_dpp v19, v23, v51 row_newbcast:2 row_mask:0xf bank_mask:0xf
    s_waitcnt lgkmcnt(0)
    s_cmp_gt_u32 s71, 43
    s_cbranch_scc1 L_ck_105
L_cs_106:
    ds_read_b32 v39, v26 offset:25856
    s_waitcnt lgkmcnt(0)
    v_readfirstlane_b32 s71, v39
    s_nop 0
    s_cmp_gt_u32 s71, 43
    s_cbranch_scc1 L_ck_105
    s_cmp_eq_u32 s83, 0
    s_cbranch_scc1 L_ck_105
    s_sub_u32 s83, s83, 1
    s_sleep 1
    s_branch L_cs_106
L_ck_105:
    ds_read_b128 v[56:59], v0 offset:24576
    v_dot2c_f32_bf16_dpp v12, v20, v52 row_newbcast:10 row_mask:0xf bank_mask:0xf
    v_dot2c_f32_bf16_dpp v13, v21, v52 row_newbcast:10 row_mask:0xf bank_mask:0xf
    v_dot2c_f32_bf16_dpp v14, v20, v53 row_newbcast:10 row_mask:0xf bank_mask:0xf
    v_dot2c_f32_bf16_dpp v15, v21, v53 row_newbcast:10 row_mask:0xf bank_mask:0xf
    v_dot2c_f32_bf16_dpp v16, v20, v54 row_newbcast:10 row_mask:0xf bank_mask:0xf
    v_dot2c_f32_bf16_dpp v17, v21, v54 row_newbcast:10 row_mask:0xf bank_mask:0xf
    v_dot2c_f32_bf16_dpp v18, v20, v55 row_newbcast:10 row_mask:0xf bank_mask:0xf
    v_dot2c_f32_bf16_dpp v19, v21, v55 row_newbcast:10 row_mask:0xf bank_mask:0xf
    v_mov_b32 v38, 44
    s_waitcnt lgkmcnt(0)
    s_mov_b64 exec, 1
    ds_write_b32 v27, v38 offset:25600
    s_mov_b64 exec, -1
    s_cmp_gt_u32 s71, 44
    s_cbranch_scc1 L_ck_107
L_cs_108:
    ds_read_b32 v39, v26 offset:25856
    s_waitcnt lgkmcnt(0)
    v_readfirstlane_b32 s71, v39
    s_nop 0
    s_cmp_gt_u32 s71, 44
    s_cbranch_scc1 L_ck_107
    s_cmp_eq_u32 s83, 0
    s_cbranch_scc1 L_ck_107
    s_sub_u32 s83, s83, 1
    s_sleep 1
    s_branch L_cs_108
L_ck_107:
    ds_read_b128 v[44:47], v0 offset:32768
    v_dot2c_f32_bf16_dpp v12, v22, v56 row_newbcast:10 row_mask:0xf bank_mask:0xf
    v_dot2c_f32_bf16_dpp v13, v23, v56 row_newbcast:10 row_mask:0xf bank_mask:0xf
    v_dot2c_f32_bf16_dpp v14, v22, v57 row_newbcast:10 row_mask:0xf bank_mask:0xf
    v_dot2c_f32_bf16_dpp v15, v23, v57 row_newbcast:10 row_mask:0xf bank_mask:0xf
    v_dot2c_f32_bf16_dpp v16, v22, v58 row_newbcast:10 row_mask:0xf bank_mask:0xf
    v_dot2c_f32_bf16_dpp v17, v23, v58 row_newbcast:10 row_mask:0xf bank_mask:0xf
    v_dot2c_f32_bf16_dpp v18, v22, v59 row_newbcast:10 row_mask:0xf bank_mask:0xf
    v_dot2c_f32_bf16_dpp v19, v23, v59 row_newbcast:10 row_mask:0xf bank_mask:0xf
    s_waitcnt vmcnt(0)
    v_mov_b32 v92, 0
    s_cmp_eq_u32 s74, 7
    s_cbranch_scc1 L_now2b
    s_cmp_gt_u32 s72, 13
    s_cbranch_scc1 L_now2c
    v_lshrrev_b32 v28, 3, v1
    s_lshl_b32 s76, s75, 5
    v_lshl_add_u32 v28, v28, 2, s76
    ds_read_b32 v32, v28 offset:640
    s_waitcnt lgkmcnt(0)
    v_and_b32 v28, 0xffff, v32
    v_lshlrev_b32 v29, 16, v32
    v_lshrrev_b32 v30, 16, v32
    v_and_b32 v31, 0xffff0000, v32
    v_dot2_f32_bf16 v92, v76, v28, 0
    v_dot2_f32_bf16 v93, v76, v29, 0
    v_dot2_f32_bf16 v94, v77, v28, 0
    v_dot2_f32_bf16 v95, v77, v29, 0
    v_dot2_f32_bf16 v96, v78, v28, 0
    v_dot2_f32_bf16 v97, v78, v29, 0
    v_dot2_f32_bf16 v98, v79, v28, 0
    v_dot2_f32_bf16 v99, v79, v29, 0
    v_dot2_f32_bf16 v92, v80, v30, v92
    v_dot2_f32_bf16 v93, v80, v31, v93
    v_dot2_f32_bf16 v94, v81, v30, v94
    v_dot2_f32_bf16 v95, v81, v31, v95
    v_dot2_f32_bf16 v96, v82, v30, v96
    v_dot2_f32_bf16 v97, v82, v31, v97
    v_dot2_f32_bf16 v98, v83, v30, v98
    v_dot2_f32_bf16 v99, v83, v31, v99
    v_permlane32_swap_b32 v92, v96
    v_permlane32_swap_b32 v93, v97
    v_permlane32_swap_b32 v94, v98
    v_permlane32_swap_b32 v95, v99
    v_add_f32 v92, v92, v96
    v_add_f32 v93, v93, v97
    v_add_f32 v94, v94, v98
    v_add_f32 v95, v95, v99
    s_nop 0
    v_permlane16_swap_b32 v92, v94
    v_permlane16_swap_b32 v93, v95
    v_add_f32 v92, v92, v94
    v_add_f32 v93, v93, v95
    s_nop 0
    v_add_f32_dpp v92, v92, v92 row_ror:8 row_mask:0xf bank_mask:0x3
    s_nop 1
    v_add_f32_dpp v92, v93, v93 row_ror:8 row_mask:0xf bank_mask:0xc
L_now2c:
    ds_write_b32 v25, v92 offset:9728
L_now2b:
    v_and_b32 v32, 31, v1
    v_lshlrev_b32 v32, 5, v32
    v_lshrrev_b32 v33, 5, v1
    v_lshl_add_u32 v32, v33, 4, v32
    s_mul_i32 s76, s75, 1056
    v_add_u32 v32, s76, v32
    s_lshl_b32 s76, s75, 10
    s_lshl_b32 s77, s73, 25
    s_add_u32 s76, s76, s77
    s_lshl_b32 s77, s72, 21
    s_add_u32 s76, s76, s77
    s_lshl_b32 s77, s74, 18
    s_add_u32 s76, s76, s77
    v_lshl_add_u32 v7, v1, 4, s76
    v_and_b32 v37, 7, v1
    v_lshrrev_b32 v36, 3, v1
    v_lshlrev_b32 v36, 4, v36
    v_mul_u32_u24 v37, 1056, v37
    v_add_u32 v36, v37, v36
    s_lshl_b32 s76, s75, 7
    v_add_u32 v36, s76, v36
    s_lshl_b32 s78, 0x01010101, s74
    s_mov_b32 s79, s78
    s_mov_b32 s80, 0x05040100
    s_mov_b32 s81, 0x07060302
    v_perm_b32 v140, v64, v60, s80
    v_perm_b32 v141, v64, v60, s81
    v_perm_b32 v142, v65, v61, s80
    v_perm_b32 v143, v65, v61, s81
    v_perm_b32 v144, v66, v62, s80
    v_perm_b32 v145, v66, v62, s81
    v_perm_b32 v146, v67, v63, s80
    v_perm_b32 v147, v67, v63, s81
    v_perm_b32 v148, v72, v68, s80
    v_perm_b32 v149, v72, v68, s81
    v_perm_b32 v150, v73, v69, s80
    v_perm_b32 v151, v73, v69, s81
    v_perm_b32 v152, v74, v70, s80
    v_perm_b32 v153, v74, v70, s81
    v_perm_b32 v154, v75, v71, s80
    v_perm_b32 v155, v75, v71, s81
    s_waitcnt lgkmcnt(0)
    s_cmp_gt_u32 s71, 45
    s_cbranch_scc1 L_ck_109
L_cs_110:
    ds_read_b32 v39, v26 offset:25856
    s_waitcnt lgkmcnt(0)
    v_readfirstlane_b32 s71, v39
    s_nop 0
    s_cmp_gt_u32 s71, 45
    s_cbranch_scc1 L_ck_109
    s_cmp_eq_u32 s83, 0
    s_cbranch_scc1 L_ck_109
    s_sub_u32 s83, s83, 1
    s_sleep 1
    s_branch L_cs_110
L_ck_109:
    ds_read_b128 v[48:51], v0 offset:40960
    v_dot2c_f32_bf16_dpp v12, v20, v44 row_newbcast:6 row_mask:0xf bank_mask:0xf
    v_dot2c_f32_bf16_dpp v13, v21, v44 row_newbcast:6 row_mask:0xf bank_mask:0xf
    v_dot2c_f32_bf16_dpp v14, v20, v45 row_newbcast:6 row_mask:0xf bank_mask:0xf
    v_dot2c_f32_bf16_dpp v15, v21, v45 row_newbcast:6 row_mask:0xf bank_mask:0xf
    v_dot2c_f32_bf16_dpp v16, v20, v46 row_newbcast:6 row_mask:0xf bank_mask:0xf
    v_dot2c_f32_bf16_dpp v17, v21, v46 row_newbcast:6 row_mask:0xf bank_mask:0xf
    v_dot2c_f32_bf16_dpp v18, v20, v47 row_newbcast:6 row_mask:0xf bank_mask:0xf
    v_dot2c_f32_bf16_dpp v19, v21, v47 row_newbcast:6 row_mask:0xf bank_mask:0xf
    v_mov_b32 v38, 46
    s_waitcnt lgkmcnt(0)
    s_mov_b64 exec, 1
    ds_write_b32 v27, v38 offset:25600
    s_mov_b64 exec, -1
    s_cmp_gt_u32 s71, 46
    s_cbranch_scc1 L_ck_111
L_cs_112:
    ds_read_b32 v39, v26 offset:25856
    s_waitcnt lgkmcnt(0)
    v_readfirstlane_b32 s71, v39
    s_nop 0
    s_cmp_gt_u32 s71, 46
    s_cbranch_scc1 L_ck_111
    s_cmp_eq_u32 s83, 0
    s_cbranch_scc1 L_ck_111
    s_sub_u32 s83, s83, 1
    s_sleep 1
    s_branch L_cs_112
L_ck_111:
    ds_read_b128 v[52:55], v0 offset:49152
    v_dot2c_f32_bf16_dpp v12, v22, v48 row_newbcast:6 row_mask:0xf bank_mask:0xf
    v_dot2c_f32_bf16_dpp v13, v23, v48 row_newbcast:6 row_mask:0xf bank_mask:0xf
    v_dot2c_f32_bf16_dpp v14, v22, v49 row_newbcast:6 row_mask:0xf bank_mask:0xf
    v_dot2c_f32_bf16_dpp v15, v23, v49 row_newbcast:6 row_mask:0xf bank_mask:0xf
    v_dot2c_f32_bf16_dpp v16, v22, v50 row_newbcast:6 row_mask:0xf bank_mask:0xf
    v_dot2c_f32_bf16_dpp v17, v23, v50 row_newbcast:6 row_mask:0xf bank_mask:0xf
    v_dot2c_f32_bf16_dpp v18, v22, v51 row_newbcast:6 row_mask:0xf bank_mask:0xf
    v_dot2c_f32_bf16_dpp v19, v23, v51 row_newbcast:6 row_mask:0xf bank_mask:0xf
    s_waitcnt lgkmcnt(0)
    s_cmp_gt_u32 s71, 47
    s_cbranch_scc1 L_ck_113
L_cs_114:
    ds_read_b32 v39, v26 offset:25856
    s_waitcnt lgkmcnt(0)
    v_readfirstlane_b32 s71, v39
    s_nop 0
    s_cmp_gt_u32 s71, 47
    s_cbranch_scc1 L_ck_113
    s_cmp_eq_u32 s83, 0
    s_cbranch_scc1 L_ck_113
    s_sub_u32 s83, s83, 1
    s_sleep 1
    s_branch L_cs_114
L_ck_113:
    ds_read_b128 v[56:59], v0 offset:57344
    v_dot2c_f32_bf16_dpp v12, v20, v52 row_newbcast:14 row_mask:0xf bank_mask:0xf
    v_dot2c_f32_bf16_dpp v13, v21, v52 row_newbcast:14 row_mask:0xf bank_mask:0xf
    v_dot2c_f32_bf16_dpp v14, v20, v53 row_newbcast:14 row_mask:0xf bank_mask:0xf
    v_dot2c_f32_bf16_dpp v15, v21, v53 row_newbcast:14 row_mask:0xf bank_mask:0xf
    v_dot2c_f32_bf16_dpp v16, v20, v54 row_newbcast:14 row_mask:0xf bank_mask:0xf
    v_dot2c_f32_bf16_dpp v17, v21, v54 row_newbcast:14 row_mask:0xf bank_mask:0xf
    v_dot2c_f32_bf16_dpp v18, v20, v55 row_newbcast:14 row_mask:0xf bank_mask:0xf
    v_dot2c_f32_bf16_dpp v19, v21, v55 row_newbcast:14 row_mask:0xf bank_mask:0xf
    v_mov_b32 v38, 48
    s_waitcnt lgkmcnt(0)
    s_mov_b64 exec, 1
    ds_write_b32 v27, v38 offset:25600
    s_mov_b64 exec, -1
    s_cmp_gt_u32 s71, 48
    s_cbranch_scc1 L_ck_115
L_cs_116:
    ds_read_b32 v39, v26 offset:25856
    s_waitcnt lgkmcnt(0)
    v_readfirstlane_b32 s71, v39
    s_nop 0
    s_cmp_gt_u32 s71, 48
    s_cbranch_scc1 L_ck_115
    s_cmp_eq_u32 s83, 0
    s_cbranch_scc1 L_ck_115
    s_sub_u32 s83, s83, 1
    s_sleep 1
    s_branch L_cs_116
L_ck_115:
    ds_read_b128 v[44:47], v2 offset:0
    v_dot2c_f32_bf16_dpp v12, v22, v56 row_newbcast:14 row_mask:0xf bank_mask:0xf
    v_dot2c_f32_bf16_dpp v13, v23, v56 row_newbcast:14 row_mask:0xf bank_mask:0xf
    v_dot2c_f32_bf16_dpp v14, v22, v57 row_newbcast:14 row_mask:0xf bank_mask:0xf
    v_dot2c_f32_bf16_dpp v15, v23, v57 row_newbcast:14 row_mask:0xf bank_mask:0xf
    v_dot2c_f32_bf16_dpp v16, v22, v58 row_newbcast:14 row_mask:0xf bank_mask:0xf
    v_dot2c_f32_bf16_dpp v17, v23, v58 row_newbcast:14 row_mask:0xf bank_mask:0xf
    v_dot2c_f32_bf16_dpp v18, v22, v59 row_newbcast:14 row_mask:0xf bank_mask:0xf
    v_dot2c_f32_bf16_dpp v19, v23, v59 row_newbcast:14 row_mask:0xf bank_mask:0xf
    buffer_load_dwordx4 v[84:87], v4, s[64:67], 0 offen offset:2048 sc1
    s_waitcnt lgkmcnt(0)
    s_cmp_gt_u32 s71, 49
    s_cbranch_scc1 L_ck_117
L_cs_118:
    ds_read_b32 v39, v26 offset:25856
    s_waitcnt lgkmcnt(0)
    v_readfirstlane_b32 s71, v39
    s_nop 0
    s_cmp_gt_u32 s71, 49
    s_cbranch_scc1 L_ck_117
    s_cmp_eq_u32 s83, 0
    s_cbranch_scc1 L_ck_117
    s_sub_u32 s83, s83, 1
    s_sleep 1
    s_branch L_cs_118
L_ck_117:
    ds_read_b128 v[48:51], v2 offset:8192
    v_dot2c_f32_bf16_dpp v12, v20, v44 row_newbcast:1 row_mask:0xf bank_mask:0xf
    v_dot2c_f32_bf16_dpp v13, v21, v44 row_newbcast:1 row_mask:0xf bank_mask:0xf
    v_dot2c_f32_bf16_dpp v14, v20, v45 row_newbcast:1 row_mask:0xf bank_mask:0xf
    v_dot2c_f32_bf16_dpp v15, v21, v45 row_newbcast:1 row_mask:0xf bank_mask:0xf
    v_dot2c_f32_bf16_dpp v16, v20, v46 row_newbcast:1 row_mask:0xf bank_mask:0xf
    v_dot2c_f32_bf16_dpp v17, v21, v46 row_newbcast:1 row_mask:0xf bank_mask:0xf
    v_dot2c_f32_bf16_dpp v18, v20, v47 row_newbcast:1 row_mask:0xf bank_mask:0xf
    v_dot2c_f32_bf16_dpp v19, v21, v47 row_newbcast:1 row_mask:0xf bank_mask:0xf
    s_waitcnt lgkmcnt(0)
    s_cmp_gt_u32 s71, 50
    s_cbranch_scc1 L_ck_119
L_cs_120:
    ds_read_b32 v39, v26 offset:25856
    s_waitcnt lgkmcnt(0)
    v_readfirstlane_b32 s71, v39
    s_nop 0
    s_cmp_gt_u32 s71, 50
    s_cbranch_scc1 L_ck_119
    s_cmp_eq_u32 s83, 0
    s_cbranch_scc1 L_ck_119
    s_sub_u32 s83, s83, 1
    s_sleep 1
    s_branch L_cs_120
L_ck_119:
    ds_read_b128 v[52:55], v2 offset:16384
    v_dot2c_f32_bf16_dpp v12, v22, v48 row_newbcast:1 row_mask:0xf bank_mask:0xf
    v_dot2c_f32_bf16_dpp v13, v23, v48 row_newbcast:1 row_mask:0xf bank_mask:0xf
    v_dot2c_f32_bf16_dpp v14, v22, v49 row_newbcast:1 row_mask:0xf bank_mask:0xf
    v_dot2c_f32_bf16_dpp v15, v23, v49 row_newbcast:1 row_mask:0xf bank_mask:0xf
    v_dot2c_f32_bf16_dpp v16, v22, v50 row_newbcast:1 row_mask:0xf bank_mask:0xf
    v_dot2c_f32_bf16_dpp v17, v23, v50 row_newbcast:1 row_mask:0xf bank_mask:0xf
    v_dot2c_f32_bf16_dpp v18, v22, v51 row_newbcast:1 row_mask:0xf bank_mask:0xf
    v_dot2c_f32_bf16_dpp v19, v23, v51 row_newbcast:1 row_mask:0xf bank_mask:0xf
    s_waitcnt lgkmcnt(0)
    s_cmp_gt_u32 s71, 51
    s_cbranch_scc1 L_ck_121
L_cs_122:
    ds_read_b32 v39, v26 offset:25856
    s_waitcnt lgkmcnt(0)
    v_readfirstlane_b32 s71, v39
    s_nop 0
    s_cmp_gt_u32 s71, 51
    s_cbranch_scc1 L_ck_121
    s_cmp_eq_u32 s83, 0
    s_cbranch_scc1 L_ck_121
    s_sub_u32 s83, s83, 1
    s_sleep 1
    s_branch L_cs_122
L_ck_121:
    ds_read_b128 v[56:59], v2 offset:24576
    v_dot2c_f32_bf16_dpp v12, v20, v52 row_newbcast:9 row_mask:0xf bank_mask:0xf
    v_dot2c_f32_bf16_dpp v13, v21, v52 row_newbcast:9 row_mask:0xf bank_mask:0xf
    v_dot2c_f32_bf16_dpp v14, v20, v53 row_newbcast:9 row_mask:0xf bank_mask:0xf
    v_dot2c_f32_bf16_dpp v15, v21, v53 row_newbcast:9 row_mask:0xf bank_mask:0xf
    v_dot2c_f32_bf16_dpp v16, v20, v54 row_newbcast:9 row_mask:0xf bank_mask:0xf
    v_dot2c_f32_bf16_dpp v17, v21, v54 row_newbcast:9 row_mask:0xf bank_mask:0xf
    v_dot2c_f32_bf16_dpp v18, v20, v55 row_newbcast:9 row_mask:0xf bank_mask:0xf
    v_dot2c_f32_bf16_dpp v19, v21, v55 row_newbcast:9 row_mask:0xf bank_mask:0xf
    s_waitcnt lgkmcnt(0)
    s_cmp_gt_u32 s71, 52
    s_cbranch_scc1 L_ck_123
L_cs_124:
    ds_read_b32 v39, v26 offset:25856
    s_waitcnt lgkmcnt(0)
    v_readfirstlane_b32 s71, v39
    s_nop 0
    s_cmp_gt_u32 s71, 52
    s_cbranch_scc1 L_ck_123
    s_cmp_eq_u32 s83, 0
    s_cbranch_scc1 L_ck_123
    s_sub_u32 s83, s83, 1
    s_sleep 1
    s_branch L_cs_124
L_ck_123:
    ds_read_b128 v[44:47], v2 offset:32768
    v_dot2c_f32_bf16_dpp v12, v22, v56 row_newbcast:9 row_mask:0xf bank_mask:0xf
    v_dot2c_f32_bf16_dpp v13, v23, v56 row_newbcast:9 row_mask:0xf bank_mask:0xf
    v_dot2c_f32_bf16_dpp v14, v22, v57 row_newbcast:9 row_mask:0xf bank_mask:0xf
    v_dot2c_f32_bf16_dpp v15, v23, v57 row_newbcast:9 row_mask:0xf bank_mask:0xf
    v_dot2c_f32_bf16_dpp v16, v22, v58 row_newbcast:9 row_mask:0xf bank_mask:0xf
    v_dot2c_f32_bf16_dpp v17, v23, v58 row_newbcast:9 row_mask:0xf bank_mask:0xf
    v_dot2c_f32_bf16_dpp v18, v22, v59 row_newbcast:9 row_mask:0xf bank_mask:0xf
    v_dot2c_f32_bf16_dpp v19, v23, v59 row_newbcast:9 row_mask:0xf bank_mask:0xf
    v_mov_b32 v28, 112
L_frdy:
    ds_read_b32 v29, v28
    ds_read_b32 v35, v26 offset:64
    s_waitcnt lgkmcnt(0)
    v_cmp_eq_u32 vcc, 1, v29
    s_cbranch_vccnz L_frdyd
    s_cmp_eq_u32 s83, 0
    s_cbranch_scc1 L_frdyd
    s_sub_u32 s83, s83, 1
    s_sleep 1
    s_branch L_frdy
L_frdyd:
    s_waitcnt vmcnt(0)
    s_cmp_lg_u32 s31, 0
    s_cbranch_scc1 L_nomlc
L_poll_125:
    v_xor_b32 v28, s68, v86
    v_bitop3_b32 v28, v28, s69, v87 bitop3:0xf6
    v_cmp_ne_u32 vcc, 0, v28
    s_cbranch_vccz L_pdone_126
    s_cmp_eq_u32 s83, 0
    s_cbranch_scc1 L_pdone_126
    s_sub_u32 s83, s83, 1
    buffer_load_dwordx4 v[84:87], v4, s[64:67], 0 offen offset:2048 sc1
    s_waitcnt vmcnt(0)
    s_branch L_poll_125
L_pdone_126:
    v_mov_b32 v28, v84
    s_nop 1
    v_max_f32_dpp v28, v28, v28 quad_perm:[1,0,3,2] row_mask:0xf bank_mask:0xf
    s_nop 1
    v_max_f32_dpp v28, v28, v28 quad_perm:[2,3,0,1] row_mask:0xf bank_mask:0xf
    s_nop 1
    v_max_f32_dpp v28, v28, v28 row_half_mirror row_mask:0xf bank_mask:0xf
    v_sub_f32 v28, v84, v28
    v_mul_f32 v28, 0x3db8aa3b, v28
    v_exp_f32 v28, v28
    s_nop 0
    v_mul_f32 v29, v28, v85
    s_nop 1
    v_add_f32_dpp v29, v29, v29 quad_perm:[1,0,3,2] row_mask:0xf bank_mask:0xf
    s_nop 1
    v_add_f32_dpp v29, v29, v29 quad_perm:[2,3,0,1] row_mask:0xf bank_mask:0xf
    s_nop 1
    v_add_f32_dpp v29, v29, v29 row_half_mirror row_mask:0xf bank_mask:0xf
    v_rcp_f32 v29, v29
    s_nop 0
    v_mul_f32 v24, v28, v29
L_nomlc:
    s_waitcnt lgkmcnt(0)
    s_cmp_gt_u32 s71, 53
    s_cbranch_scc1 L_ck_127
L_cs_128:
    ds_read_b32 v39, v26 offset:25856
    s_waitcnt lgkmcnt(0)
    v_readfirstlane_b32 s71, v39
    s_nop 0
    s_cmp_gt_u32 s71, 53
    s_cbranch_scc1 L_ck_127
    s_cmp_eq_u32 s83, 0
    s_cbranch_scc1 L_ck_127
    s_sub_u32 s83, s83, 1
    s_sleep 1
    s_branch L_cs_128
L_ck_127:
    ds_read_b128 v[48:51], v2 offset:40960
    v_dot2c_f32_bf16_dpp v12, v20, v44 row_newbcast:5 row_mask:0xf bank_mask:0xf
    v_dot2c_f32_bf16_dpp v13, v21, v44 row_newbcast:5 row_mask:0xf bank_mask:0xf
    v_dot2c_f32_bf16_dpp v14, v20, v45 row_newbcast:5 row_mask:0xf bank_mask:0xf
    v_dot2c_f32_bf16_dpp v15, v21, v45 row_newbcast:5 row_mask:0xf bank_mask:0xf
    v_dot2c_f32_bf16_dpp v16, v20, v46 row_newbcast:5 row_mask:0xf bank_mask:0xf
    v_dot2c_f32_bf16_dpp v17, v21, v46 row_newbcast:5 row_mask:0xf bank_mask:0xf
    v_dot2c_f32_bf16_dpp v18, v20, v47 row_newbcast:5 row_mask:0xf bank_mask:0xf
    v_dot2c_f32_bf16_dpp v19, v21, v47 row_newbcast:5 row_mask:0xf bank_mask:0xf
    s_waitcnt lgkmcnt(0)
    s_cmp_gt_u32 s71, 54
    s_cbranch_scc1 L_ck_129
L_cs_130:
    ds_read_b32 v39, v26 offset:25856
    s_waitcnt lgkmcnt(0)
    v_readfirstlane_b32 s71, v39
    s_nop 0
    s_cmp_gt_u32 s71, 54
    s_cbranch_scc1 L_ck_129
    s_cmp_eq_u32 s83, 0
    s_cbranch_scc1 L_ck_129
    s_sub_u32 s83, s83, 1
    s_sleep 1
    s_branch L_cs_130
L_ck_129:
    ds_read_b128 v[52:55], v2 offset:49152
    v_dot2c_f32_bf16_dpp v12, v22, v48 row_newbcast:5 row_mask:0xf bank_mask:0xf
    v_dot2c_f32_bf16_dpp v13, v23, v48 row_newbcast:5 row_mask:0xf bank_mask:0xf
    v_dot2c_f32_bf16_dpp v14, v22, v49 row_newbcast:5 row_mask:0xf bank_mask:0xf
    v_dot2c_f32_bf16_dpp v15, v23, v49 row_newbcast:5 row_mask:0xf bank_mask:0xf
    v_dot2c_f32_bf16_dpp v16, v22, v50 row_newbcast:5 row_mask:0xf bank_mask:0xf
    v_dot2c_f32_bf16_dpp v17, v23, v50 row_newbcast:5 row_mask:0xf bank_mask:0xf
    v_dot2c_f32_bf16_dpp v18, v22, v51 row_newbcast:5 row_mask:0xf bank_mask:0xf
    v_dot2c_f32_bf16_dpp v19, v23, v51 row_newbcast:5 row_mask:0xf bank_mask:0xf
    s_waitcnt lgkmcnt(0)
    s_cmp_gt_u32 s71, 55
    s_cbranch_scc1 L_ck_131
L_cs_132:
    ds_read_b32 v39, v26 offset:25856
    s_waitcnt lgkmcnt(0)
    v_readfirstlane_b32 s71, v39
    s_nop 0
    s_cmp_gt_u32 s71, 55
    s_cbranch_scc1 L_ck_131
    s_cmp_eq_u32 s83, 0
    s_cbranch_scc1 L_ck_131
    s_sub_u32 s83, s83, 1
    s_sleep 1
    s_branch L_cs_132
L_ck_131:
    ds_read_b128 v[56:59], v2 offset:57344
    v_dot2c_f32_bf16_dpp v12, v20, v52 row_newbcast:13 row_mask:0xf bank_mask:0xf
    v_dot2c_f32_bf16_dpp v13, v21, v52 row_newbcast:13 row_mask:0xf bank_mask:0xf
    v_dot2c_f32_bf16_dpp v14, v20, v53 row_newbcast:13 row_mask:0xf bank_mask:0xf
    v_dot2c_f32_bf16_dpp v15, v21, v53 row_newbcast:13 row_mask:0xf bank_mask:0xf
    v_dot2c_f32_bf16_dpp v16, v20, v54 row_newbcast:13 row_mask:0xf bank_mask:0xf
    v_dot2c_f32_bf16_dpp v17, v21, v54 row_newbcast:13 row_mask:0xf bank_mask:0xf
    v_dot2c_f32_bf16_dpp v18, v20, v55 row_newbcast:13 row_mask:0xf bank_mask:0xf
    v_dot2c_f32_bf16_dpp v19, v21, v55 row_newbcast:13 row_mask:0xf bank_mask:0xf
    s_waitcnt lgkmcnt(0)
    s_cmp_gt_u32 s71, 56
    s_cbranch_scc1 L_ck_133
L_cs_134:
    ds_read_b32 v39, v26 offset:25856
    s_waitcnt lgkmcnt(0)
    v_readfirstlane_b32 s71, v39
    s_nop 0
    s_cmp_gt_u32 s71, 56
    s_cbranch_scc1 L_ck_133
    s_cmp_eq_u32 s83, 0
    s_cbranch_scc1 L_ck_133
    s_sub_u32 s83, s83, 1
    s_sleep 1
    s_branch L_cs_134
L_ck_133:
    ds_read_b128 v[44:47], v0 offset:0
    v_dot2c_f32_bf16_dpp v12, v22, v56 row_newbcast:13 row_mask:0xf bank_mask:0xf
    v_dot2c_f32_bf16_dpp v13, v23, v56 row_newbcast:13 row_mask:0xf bank_mask:0xf
    v_dot2c_f32_bf16_dpp v14, v22, v57 row_newbcast:13 row_mask:0xf bank_mask:0xf
    v_dot2c_f32_bf16_dpp v15, v23, v57 row_newbcast:13 row_mask:0xf bank_mask:0xf
    v_dot2c_f32_bf16_dpp v16, v22, v58 row_newbcast:13 row_mask:0xf bank_mask:0xf
    v_dot2c_f32_bf16_dpp v17, v23, v58 row_newbcast:13 row_mask:0xf bank_mask:0xf
    v_dot2c_f32_bf16_dpp v18, v22, v59 row_newbcast:13 row_mask:0xf bank_mask:0xf
    v_dot2c_f32_bf16_dpp v19, v23, v59 row_newbcast:13 row_mask:0xf bank_mask:0xf
    s_waitcnt lgkmcnt(0)
    v_dot2c_f32_bf16_dpp v12, v20, v44 row_newbcast:3 row_mask:0xf bank_mask:0xf
    v_dot2c_f32_bf16_dpp v13, v21, v44 row_newbcast:3 row_mask:0xf bank_mask:0xf
    v_dot2c_f32_bf16_dpp v14, v20, v45 row_newbcast:3 row_mask:0xf bank_mask:0xf
    v_dot2c_f32_bf16_dpp v15, v21, v45 row_newbcast:3 row_mask:0xf bank_mask:0xf
    v_dot2c_f32_bf16_dpp v16, v20, v46 row_newbcast:3 row_mask:0xf bank_mask:0xf
    v_dot2c_f32_bf16_dpp v17, v21, v46 row_newbcast:3 row_mask:0xf bank_mask:0xf
    v_dot2c_f32_bf16_dpp v18, v20, v47 row_newbcast:3 row_mask:0xf bank_mask:0xf
    v_dot2c_f32_bf16_dpp v19, v21, v47 row_newbcast:3 row_mask:0xf bank_mask:0xf
    s_cmp_gt_u32 s71, 57
    s_cbranch_scc1 L_ck_135
L_cs_136:
    ds_read_b32 v39, v26 offset:25856
    s_waitcnt lgkmcnt(0)
    v_readfirstlane_b32 s71, v39
    s_nop 0
    s_cmp_gt_u32 s71, 57
    s_cbranch_scc1 L_ck_135
    s_cmp_eq_u32 s83, 0
    s_cbranch_scc1 L_ck_135
    s_sub_u32 s83, s83, 1
    s_sleep 1
    s_branch L_cs_136
L_ck_135:
    ds_read_b128 v[48:51], v0 offset:8192
    s_waitcnt lgkmcnt(0)
    v_dot2c_f32_bf16_dpp v12, v22, v48 row_newbcast:3 row_mask:0xf bank_mask:0xf
    v_dot2c_f32_bf16_dpp v13, v23, v48 row_newbcast:3 row_mask:0xf bank_mask:0xf
    v_dot2c_f32_bf16_dpp v14, v22, v49 row_newbcast:3 row_mask:0xf bank_mask:0xf
    v_dot2c_f32_bf16_dpp v15, v23, v49 row_newbcast:3 row_mask:0xf bank_mask:0xf
    v_dot2c_f32_bf16_dpp v16, v22, v50 row_newbcast:3 row_mask:0xf bank_mask:0xf
    v_dot2c_f32_bf16_dpp v17, v23, v50 row_newbcast:3 row_mask:0xf bank_mask:0xf
    v_dot2c_f32_bf16_dpp v18, v22, v51 row_newbcast:3 row_mask:0xf bank_mask:0xf
    v_dot2c_f32_bf16_dpp v19, v23, v51 row_newbcast:3 row_mask:0xf bank_mask:0xf
    s_cmp_gt_u32 s71, 58
    s_cbranch_scc1 L_ck_137
L_cs_138:
    ds_read_b32 v39, v26 offset:25856
    s_waitcnt lgkmcnt(0)
    v_readfirstlane_b32 s71, v39
    s_nop 0
    s_cmp_gt_u32 s71, 58
    s_cbranch_scc1 L_ck_137
    s_cmp_eq_u32 s83, 0
    s_cbranch_scc1 L_ck_137
    s_sub_u32 s83, s83, 1
    s_sleep 1
    s_branch L_cs_138
L_ck_137:
    ds_read_b128 v[52:55], v0 offset:16384
    s_waitcnt lgkmcnt(0)
    v_dot2c_f32_bf16_dpp v12, v20, v52 row_newbcast:11 row_mask:0xf bank_mask:0xf
    v_dot2c_f32_bf16_dpp v13, v21, v52 row_newbcast:11 row_mask:0xf bank_mask:0xf
    v_dot2c_f32_bf16_dpp v14, v20, v53 row_newbcast:11 row_mask:0xf bank_mask:0xf
    v_dot2c_f32_bf16_dpp v15, v21, v53 row_newbcast:11 row_mask:0xf bank_mask:0xf
    v_dot2c_f32_bf16_dpp v16, v20, v54 row_newbcast:11 row_mask:0xf bank_mask:0xf
    v_dot2c_f32_bf16_dpp v17, v21, v54 row_newbcast:11 row_mask:0xf bank_mask:0xf
    v_dot2c_f32_bf16_dpp v18, v20, v55 row_newbcast:11 row_mask:0xf bank_mask:0xf
    v_dot2c_f32_bf16_dpp v19, v21, v55 row_newbcast:11 row_mask:0xf bank_mask:0xf
    s_cmp_gt_u32 s71, 59
    s_cbranch_scc1 L_ck_139
L_cs_140:
    ds_read_b32 v39, v26 offset:25856
    s_waitcnt lgkmcnt(0)
    v_readfirstlane_b32 s71, v39
    s_nop 0
    s_cmp_gt_u32 s71, 59
    s_cbranch_scc1 L_ck_139
    s_cmp_eq_u32 s83, 0
    s_cbranch_scc1 L_ck_139
    s_sub_u32 s83, s83, 1
    s_sleep 1
    s_branch L_cs_140
L_ck_139:
    ds_read_b128 v[56:59], v0 offset:24576
    s_mov_b32 s3, 253952
    buffer_load_dwordx4 v[100:103], v7, s[32:35], s3 offen nt
    s_waitcnt lgkmcnt(0)
    v_dot2c_f32_bf16_dpp v12, v22, v56 row_newbcast:11 row_mask:0xf bank_mask:0xf
    v_dot2c_f32_bf16_dpp v13, v23, v56 row_newbcast:11 row_mask:0xf bank_mask:0xf
    v_dot2c_f32_bf16_dpp v14, v22, v57 row_newbcast:11 row_mask:0xf bank_mask:0xf
    v_dot2c_f32_bf16_dpp v15, v23, v57 row_newbcast:11 row_mask:0xf bank_mask:0xf
    v_dot2c_f32_bf16_dpp v16, v22, v58 row_newbcast:11 row_mask:0xf bank_mask:0xf
    v_dot2c_f32_bf16_dpp v17, v23, v58 row_newbcast:11 row_mask:0xf bank_mask:0xf
    v_dot2c_f32_bf16_dpp v18, v22, v59 row_newbcast:11 row_mask:0xf bank_mask:0xf
    v_dot2c_f32_bf16_dpp v19, v23, v59 row_newbcast:11 row_mask:0xf bank_mask:0xf
    s_cmp_gt_u32 s71, 60
    s_cbranch_scc1 L_ck_141
L_cs_142:
    ds_read_b32 v39, v26 offset:25856
    s_waitcnt lgkmcnt(0)
    v_readfirstlane_b32 s71, v39
    s_nop 0
    s_cmp_gt_u32 s71, 60
    s_cbranch_scc1 L_ck_141
    s_cmp_eq_u32 s83, 0
    s_cbranch_scc1 L_ck_141
    s_sub_u32 s83, s83, 1
    s_sleep 1
    s_branch L_cs_142
L_ck_141:
    ds_read_b128 v[44:47], v0 offset:32768
    s_waitcnt lgkmcnt(0)
    v_dot2c_f32_bf16_dpp v12, v20, v44 row_newbcast:7 row_mask:0xf bank_mask:0xf
    v_dot2c_f32_bf16_dpp v13, v21, v44 row_newbcast:7 row_mask:0xf bank_mask:0xf
    v_dot2c_f32_bf16_dpp v14, v20, v45 row_newbcast:7 row_mask:0xf bank_mask:0xf
    v_dot2c_f32_bf16_dpp v15, v21, v45 row_newbcast:7 row_mask:0xf bank_mask:0xf
    v_dot2c_f32_bf16_dpp v16, v20, v46 row_newbcast:7 row_mask:0xf bank_mask:0xf
    v_dot2c_f32_bf16_dpp v17, v21, v46 row_newbcast:7 row_mask:0xf bank_mask:0xf
    v_dot2c_f32_bf16_dpp v18, v20, v47 row_newbcast:7 row_mask:0xf bank_mask:0xf
    v_dot2c_f32_bf16_dpp v19, v21, v47 row_newbcast:7 row_mask:0xf bank_mask:0xf
    s_cmp_gt_u32 s71, 61
    s_cbranch_scc1 L_ck_143
L_cs_144:
    ds_read_b32 v39, v26 offset:25856
    s_waitcnt lgkmcnt(0)
    v_readfirstlane_b32 s71, v39
    s_nop 0
    s_cmp_gt_u32 s71, 61
    s_cbranch_scc1 L_ck_143
    s_cmp_eq_u32 s83, 0
    s_cbranch_scc1 L_ck_143
    s_sub_u32 s83, s83, 1
    s_branch L_cs_144
L_ck_143:
    ds_read_b128 v[48:51], v0 offset:40960
    s_waitcnt lgkmcnt(0)
    v_dot2c_f32_bf16_dpp v12, v22, v48 row_newbcast:7 row_mask:0xf bank_mask:0xf
    v_dot2c_f32_bf16_dpp v13, v23, v48 row_newbcast:7 row_mask:0xf bank_mask:0xf
    v_dot2c_f32_bf16_dpp v14, v22, v49 row_newbcast:7 row_mask:0xf bank_mask:0xf
    v_dot2c_f32_bf16_dpp v15, v23, v49 row_newbcast:7 row_mask:0xf bank_mask:0xf
    v_dot2c_f32_bf16_dpp v16, v22, v50 row_newbcast:7 row_mask:0xf bank_mask:0xf
    v_dot2c_f32_bf16_dpp v17, v23, v50 row_newbcast:7 row_mask:0xf bank_mask:0xf
    v_dot2c_f32_bf16_dpp v18, v22, v51 row_newbcast:7 row_mask:0xf bank_mask:0xf
    v_dot2c_f32_bf16_dpp v19, v23, v51 row_newbcast:7 row_mask:0xf bank_mask:0xf
    s_cmp_gt_u32 s71, 62
    s_cbranch_scc1 L_ck_145
L_cs_146:
    ds_read_b32 v39, v26 offset:25856
    s_waitcnt lgkmcnt(0)
    v_readfirstlane_b32 s71, v39
    s_nop 0
    s_cmp_gt_u32 s71, 62
    s_cbranch_scc1 L_ck_145
    s_cmp_eq_u32 s83, 0
    s_cbranch_scc1 L_ck_145
    s_sub_u32 s83, s83, 1
    s_branch L_cs_146
L_ck_145:
    ds_read_b128 v[52:55], v0 offset:49152
    s_waitcnt lgkmcnt(0)
    v_dot2c_f32_bf16_dpp v12, v20, v52 row_newbcast:15 row_mask:0xf bank_mask:0xf
    v_dot2c_f32_bf16_dpp v13, v21, v52 row_newbcast:15 row_mask:0xf bank_mask:0xf
    v_dot2c_f32_bf16_dpp v14, v20, v53 row_newbcast:15 row_mask:0xf bank_mask:0xf
    v_dot2c_f32_bf16_dpp v15, v21, v53 row_newbcast:15 row_mask:0xf bank_mask:0xf
    v_dot2c_f32_bf16_dpp v16, v20, v54 row_newbcast:15 row_mask:0xf bank_mask:0xf
    v_dot2c_f32_bf16_dpp v17, v21, v54 row_newbcast:15 row_mask:0xf bank_mask:0xf
    v_dot2c_f32_bf16_dpp v18, v20, v55 row_newbcast:15 row_mask:0xf bank_mask:0xf
    v_dot2c_f32_bf16_dpp v19, v21, v55 row_newbcast:15 row_mask:0xf bank_mask:0xf
    s_waitcnt vmcnt(0)
    v_dot2c_f32_bf16_dpp v12, v22, v100 row_newbcast:15 row_mask:0xf bank_mask:0xf
    v_dot2c_f32_bf16_dpp v13, v23, v100 row_newbcast:15 row_mask:0xf bank_mask:0xf
    v_dot2c_f32_bf16_dpp v14, v22, v101 row_newbcast:15 row_mask:0xf bank_mask:0xf
    v_dot2c_f32_bf16_dpp v15, v23, v101 row_newbcast:15 row_mask:0xf bank_mask:0xf
    v_dot2c_f32_bf16_dpp v16, v22, v102 row_newbcast:15 row_mask:0xf bank_mask:0xf
    v_dot2c_f32_bf16_dpp v17, v23, v102 row_newbcast:15 row_mask:0xf bank_mask:0xf
    v_dot2c_f32_bf16_dpp v18, v22, v103 row_newbcast:15 row_mask:0xf bank_mask:0xf
    v_dot2c_f32_bf16_dpp v19, v23, v103 row_newbcast:15 row_mask:0xf bank_mask:0xf
L_tail:
    v_permlane32_swap_b32 v12, v16
    v_permlane32_swap_b32 v13, v17
    v_permlane32_swap_b32 v14, v18
    v_permlane32_swap_b32 v15, v19
    v_add_f32 v12, v12, v16
    v_add_f32 v13, v13, v17
    v_add_f32 v14, v14, v18
    v_add_f32 v15, v15, v19
    v_mul_f32 v12, v35, v12
    v_mul_f32 v13, v35, v13
    v_mul_f32 v14, v35, v14
    v_mul_f32 v15, v35, v15
    ds_write_b128 v32, v[12:15] offset:1024
    s_waitcnt lgkmcnt(0)
    s_barrier
    s_cmp_lg_u32 s31, 0
    s_cbranch_scc1 L_remote
    ds_read_b128 v[104:107], v36 offset:1024
    s_cmp_eq_u32 s74, 7
    s_cbranch_scc1 L_nopl
    buffer_load_dwordx4 v[128:131], v5, s[64:67], 0 offen sc1
L_nopl:
    s_waitcnt lgkmcnt(0)
    v_add_f32_dpp v104, v104, v104 quad_perm:[1,0,3,2] row_mask:0xf bank_mask:0xf
    v_add_f32_dpp v105, v105, v105 quad_perm:[1,0,3,2] row_mask:0xf bank_mask:0xf
    v_add_f32_dpp v106, v106, v106 quad_perm:[1,0,3,2] row_mask:0xf bank_mask:0xf
    v_add_f32_dpp v107, v107, v107 quad_perm:[1,0,3,2] row_mask:0xf bank_mask:0xf
    v_add_f32_dpp v104, v104, v104 quad_perm:[2,3,0,1] row_mask:0xf bank_mask:0xf
    v_add_f32_dpp v105, v105, v105 quad_perm:[2,3,0,1] row_mask:0xf bank_mask:0xf
    v_add_f32_dpp v106, v106, v106 quad_perm:[2,3,0,1] row_mask:0xf bank_mask:0xf
    v_add_f32_dpp v107, v107, v107 quad_perm:[2,3,0,1] row_mask:0xf bank_mask:0xf
    v_add_f32_dpp v104, v104, v104 row_half_mirror row_mask:0xf bank_mask:0xf
    v_add_f32_dpp v105, v105, v105 row_half_mirror row_mask:0xf bank_mask:0xf
    v_add_f32_dpp v106, v106, v106 row_half_mirror row_mask:0xf bank_mask:0xf
    v_add_f32_dpp v107, v107, v107 row_half_mirror row_mask:0xf bank_mask:0xf
    v_min_u32 v104, -2, v104
    v_min_u32 v105, -2, v105
    v_min_u32 v106, -2, v106
    v_min_u32 v107, -2, v107
    s_mov_b64 exec, s[78:79]
    buffer_store_dwordx4 v[104:107], v5, s[64:67], 0 offen
    s_mov_b64 exec, -1
    s_cmp_eq_u32 s74, 7
    s_cbranch_scc1 L_fin
    s_waitcnt vmcnt(1)
    v_cndmask_b32 v128, v128, v104, s[78:79]
    v_cndmask_b32 v129, v129, v105, s[78:79]
    v_cndmask_b32 v130, v130, v106, s[78:79]
    v_cndmask_b32 v131, v131, v107, s[78:79]
L_h1:
    v_max3_u32 v28, v128, v129, v130
    v_max_u32 v28, v28, v131
    v_cmp_eq_u32 vcc, -1, v28
    s_cbranch_vccz L_h1d
    s_cmp_eq_u32 s83, 0
    s_cbranch_scc1 L_h1d
    s_sub_u32 s83, s83, 1
    s_mov_b64 exec, vcc
    buffer_load_dwordx4 v[128:131], v5, s[64:67], 0 offen sc1
    s_mov_b64 exec, -1
    s_waitcnt vmcnt(0)
    s_branch L_h1
L_h1d:
    v_mul_f32 v108, v24, v128
    v_mul_f32 v110, v24, v129
    v_mul_f32 v112, v24, v130
    v_mul_f32 v114, v24, v131
L_hop1d:
    v_add_f32_dpp v108, v108, v108 quad_perm:[1,0,3,2] row_mask:0xf bank_mask:0xf
    v_add_f32_dpp v110, v110, v110 quad_perm:[1,0,3,2] row_mask:0xf bank_mask:0xf
    v_add_f32_dpp v112, v112, v112 quad_perm:[1,0,3,2] row_mask:0xf bank_mask:0xf
    v_add_f32_dpp v114, v114, v114 quad_perm:[1,0,3,2] row_mask:0xf bank_mask:0xf
    v_add_f32_dpp v108, v108, v108 quad_perm:[2,3,0,1] row_mask:0xf bank_mask:0xf
    v_add_f32_dpp v110, v110, v110 quad_perm:[2,3,0,1] row_mask:0xf bank_mask:0xf
    v_add_f32_dpp v112, v112, v112 quad_perm:[2,3,0,1] row_mask:0xf bank_mask:0xf
    v_add_f32_dpp v114, v114, v114 quad_perm:[2,3,0,1] row_mask:0xf bank_mask:0xf
    v_add_f32_dpp v108, v108, v108 row_half_mirror row_mask:0xf bank_mask:0xf
    v_add_f32_dpp v110, v110, v110 row_half_mirror row_mask:0xf bank_mask:0xf
    v_add_f32_dpp v112, v112, v112 row_half_mirror row_mask:0xf bank_mask:0xf
    v_add_f32_dpp v114, v114, v114 row_half_mirror row_mask:0xf bank_mask:0xf
    v_cvt_pk_bf16_f32 v108, v108, v110
    v_cvt_pk_bf16_f32 v112, v112, v114
    v_dot2_f32_bf16 v12, v140, v108, 0
    v_dot2_f32_bf16 v13, v141, v108, 0
    v_dot2_f32_bf16 v14, v142, v108, 0
    v_dot2_f32_bf16 v15, v143, v108, 0
    v_dot2_f32_bf16 v16, v144, v108, 0
    v_dot2_f32_bf16 v17, v145, v108, 0
    v_dot2_f32_bf16 v18, v146, v108, 0
    v_dot2_f32_bf16 v19, v147, v108, 0
    v_dot2_f32_bf16 v12, v148, v112, v12
    v_dot2_f32_bf16 v13, v149, v112, v13
    v_dot2_f32_bf16 v14, v150, v112, v14
    v_dot2_f32_bf16 v15, v151, v112, v15
    v_dot2_f32_bf16 v16, v152, v112, v16
    v_dot2_f32_bf16 v17, v153, v112, v17
    v_dot2_f32_bf16 v18, v154, v112, v18
    v_dot2_f32_bf16 v19, v155, v112, v19
    v_permlane32_swap_b32 v12, v16
    v_permlane32_swap_b32 v13, v17
    v_permlane32_swap_b32 v14, v18
    v_permlane32_swap_b32 v15, v19
    v_add_f32 v12, v12, v16
    v_add_f32 v13, v13, v17
    v_add_f32 v14, v14, v18
    v_add_f32 v15, v15, v19
    s_nop 0
    v_permlane16_swap_b32 v12, v14
    v_permlane16_swap_b32 v13, v15
    v_add_f32 v12, v12, v14
    v_add_f32 v13, v13, v15
    s_nop 0
    v_add_f32_dpp v12, v12, v12 row_ror:8 row_mask:0xf bank_mask:0x3
    s_nop 1
    v_add_f32_dpp v12, v13, v13 row_ror:8 row_mask:0xf bank_mask:0xc
    ds_write_b32 v25, v12 offset:11776
    v_and_b32 v36, 31, v1
    v_lshlrev_b32 v36, 3, v36
    s_add_u32 s77, s70, 6656
    v_lshl_add_u32 v37, v36, 1, s77
    v_mov_b32 v121, s68
    v_mov_b32 v123, s69
    v_lshrrev_b32 v33, 5, v1
    v_lshl_add_u32 v36, v33, 10, v36
    s_waitcnt lgkmcnt(0)
    s_barrier
    s_cmp_lg_u32 s75, 0
    s_cbranch_scc1 L_fin
    ds_read_b64 v[104:105], v36 offset:11776
    ds_read_b64 v[106:107], v36 offset:12032
    ds_read_b64 v[108:109], v36 offset:12288
    ds_read_b64 v[110:111], v36 offset:12544
    s_waitcnt lgkmcnt(0)
    v_add_f32 v104, v104, v106
    v_add_f32 v105, v105, v107
    v_add_f32 v108, v108, v110
    v_add_f32 v109, v109, v111
    v_add_f32 v104, v104, v108
    v_add_f32 v105, v105, v109
    v_mov_b32 v106, v104
    v_mov_b32 v107, v105
    s_nop 0
    v_permlane32_swap_b32 v104, v106
    v_permlane32_swap_b32 v105, v107
    v_add_f32 v120, v104, v106
    v_add_f32 v122, v105, v107
    buffer_store_dwordx4 v[120:123], v37, s[64:67], 0 offen sc1
    s_branch L_fin
L_remote:
    s_cbranch_execz L_fin
    s_mov_b32 s4, 2097152
    v_mov_b32 v121, s68
    v_mov_b32 v123, s69
    s_cmp_gt_u32 s75, 2
    s_cbranch_scc1 L_rem1
    s_cmp_eq_u32 s75, 2
    s_cbranch_scc1 L_remml
    s_lshl_b32 s76, s75, 9
    v_lshl_add_u32 v36, v1, 3, s76
    s_add_u32 s77, s70, 4096
    v_lshl_add_u32 v37, v36, 1, s77
    ds_read_b64 v[104:105], v36 offset:1024
    ds_read_b64 v[106:107], v36 offset:2080
    ds_read_b64 v[108:109], v36 offset:3136
    ds_read_b64 v[110:111], v36 offset:4192
    ds_read_b64 v[112:113], v36 offset:5248
    ds_read_b64 v[114:115], v36 offset:6304
    ds_read_b64 v[116:117], v36 offset:7360
    ds_read_b64 v[118:119], v36 offset:8416
    s_waitcnt lgkmcnt(0)
    v_add_f32 v104, v104, v106
    v_add_f32 v105, v105, v107
    v_add_f32 v108, v108, v110
    v_add_f32 v109, v109, v111
    v_add_f32 v112, v112, v114
    v_add_f32 v113, v113, v115
    v_add_f32 v116, v116, v118
    v_add_f32 v117, v117, v119
    v_add_f32 v104, v104, v108
    v_add_f32 v105, v105, v109
    v_add_f32 v112, v112, v116
    v_add_f32 v113, v113, v117
    v_add_f32 v120, v104, v112
    v_add_f32 v122, v105, v113
    s_branch L_remst
L_remml:
    v_mov_b32 v36, 25568
    ds_read_b128 v[120:123], v36
    s_add_u32 s77, s70, 6144
    v_mov_b32 v37, s77
    s_waitcnt lgkmcnt(0)
L_remst:
    buffer_store_dwordx4 v[120:123], v37, s[64:67], s4 offen sc1
L_rem1:
    s_cmp_eq_u32 s74, 7
    s_cbranch_scc1 L_fin
    v_sub_u32 v36, v5, v4
    v_lshl_add_u32 v36, v36, 1, v4
L_poll_147:
    v_xor_b32 v28, s68, v86
    v_bitop3_b32 v28, v28, s69, v87 bitop3:0xf6
    v_cmp_ne_u32 vcc, 0, v28
    s_cbranch_vccz L_pdone_148
    s_cmp_eq_u32 s83, 0
    s_cbranch_scc1 L_pdone_148
    s_sub_u32 s83, s83, 1
    buffer_load_dwordx4 v[84:87], v4, s[64:67], s4 offen offset:2048 sc1
    s_waitcnt vmcnt(0)
    s_branch L_poll_147
L_pdone_148:
    v_mov_b32 v28, v84
    s_nop 1
    v_max_f32_dpp v28, v28, v28 quad_perm:[1,0,3,2] row_mask:0xf bank_mask:0xf
    s_nop 1
    v_max_f32_dpp v28, v28, v28 quad_perm:[2,3,0,1] row_mask:0xf bank_mask:0xf
    s_nop 1
    v_max_f32_dpp v28, v28, v28 row_half_mirror row_mask:0xf bank_mask:0xf
    v_sub_f32 v28, v84, v28
    v_mul_f32 v28, 0x3db8aa3b, v28
    v_exp_f32 v28, v28
    s_nop 0
    v_mul_f32 v29, v28, v85
    s_nop 1
    v_add_f32_dpp v29, v29, v29 quad_perm:[1,0,3,2] row_mask:0xf bank_mask:0xf
    s_nop 1
    v_add_f32_dpp v29, v29, v29 quad_perm:[2,3,0,1] row_mask:0xf bank_mask:0xf
    s_nop 1
    v_add_f32_dpp v29, v29, v29 row_half_mirror row_mask:0xf bank_mask:0xf
    v_rcp_f32 v29, v29
    s_nop 0
    v_mul_f32 v24, v28, v29
    buffer_load_dwordx4 v[128:131], v36, s[64:67], s4 offen sc1
    buffer_load_dwordx4 v[132:135], v36, s[64:67], s4 offen offset:16 sc1
    s_waitcnt vmcnt(0)
L_poll_149:
    v_xor_b32 v28, s68, v129
    v_xor_b32 v29, s69, v131
    v_bitop3_b32 v28, v28, s68, v133 bitop3:0xf6
    v_bitop3_b32 v29, v29, s69, v135 bitop3:0xf6
    v_or_b32 v28, v28, v29
    v_cmp_ne_u32 vcc, 0, v28
    s_cbranch_vccz L_pdone_150
    s_cmp_eq_u32 s83, 0
    s_cbranch_scc1 L_pdone_150
    s_sub_u32 s83, s83, 1
    buffer_load_dwordx4 v[128:131], v36, s[64:67], s4 offen sc1
    buffer_load_dwordx4 v[132:135], v36, s[64:67], s4 offen offset:16 sc1
    s_waitcnt vmcnt(0)
    s_branch L_poll_149
L_pdone_150:
    v_mul_f32 v108, v24, v128
    v_mul_f32 v110, v24, v130
    v_mul_f32 v112, v24, v132
    v_mul_f32 v114, v24, v134
    s_branch L_hop1d
L_lsvc:
    s_lshl_b32 s70, s2, 13
    v_and_b32 v36, 31, v1
    v_lshlrev_b32 v36, 3, v36
    s_add_u32 s77, s70, 7168
    v_lshl_add_u32 v37, v36, 1, s77
    v_mov_b32 v121, s68
    v_mov_b32 v123, s69
    s_barrier
    s_cmp_eq_u32 s74, 7
    s_cbranch_scc1 L_red
    ds_read_b64 v[104:105], v36 offset:9728
    ds_read_b64 v[106:107], v36 offset:9984
    ds_read_b64 v[108:109], v36 offset:10240
    ds_read_b64 v[110:111], v36 offset:10496
    ds_read_b64 v[112:113], v36 offset:10752
    ds_read_b64 v[114:115], v36 offset:11008
    ds_read_b64 v[116:117], v36 offset:11264
    ds_read_b64 v[118:119], v36 offset:11520
    s_waitcnt lgkmcnt(0)
    v_add_f32 v104, v104, v106
    v_add_f32 v105, v105, v107
    v_add_f32 v108, v108, v110
    v_add_f32 v109, v109, v111
    v_add_f32 v112, v112, v114
    v_add_f32 v113, v113, v115
    v_add_f32 v116, v116, v118
    v_add_f32 v117, v117, v119
    v_add_f32 v104, v104, v108
    v_add_f32 v105, v105, v109
    v_add_f32 v112, v112, v116
    v_add_f32 v113, v113, v117
    v_add_f32 v120, v104, v112
    v_add_f32 v122, v105, v113
    buffer_store_dwordx4 v[120:123], v37, s[64:67], 0 offen sc1
    s_branch L_fin
L_red:
    s_cmp_gt_u32 s72, 6
    s_cbranch_scc1 L_fin
    s_mov_b32 s74, s72
    s_lshl_b32 s76, s74, 1
    s_add_u32 s76, s76, s73
    s_lshl_b32 s76, s76, 17
    s_add_u32 s76, s76, 6656
    v_lshrrev_b32 v33, 5, v1
    v_lshlrev_b32 v28, 13, v33
    v_lshl_add_u32 v28, v36, 1, v28
    v_add_u32 v3, s76, v28
    v_mov_b32 v30, 116
    ds_read_b32 v31, v30
    s_mov_b32 s4, 16384
    s_mov_b32 s5, 32768
    s_mov_b32 s6, 49152
    s_mov_b32 s7, 65536
    s_mov_b32 s8, 81920
    s_mov_b32 s9, 98304
    s_mov_b32 s10, 114688
    buffer_load_dwordx4 v[40:43], v3, s[64:67], 0 offen offset:512 sc1
    buffer_load_dwordx4 v[44:47], v3, s[64:67], s4 offen offset:512 sc1
    buffer_load_dwordx4 v[48:51], v3, s[64:67], s5 offen offset:512 sc1
    buffer_load_dwordx4 v[52:55], v3, s[64:67], s6 offen offset:512 sc1
    buffer_load_dwordx4 v[56:59], v3, s[64:67], s7 offen offset:512 sc1
    buffer_load_dwordx4 v[60:63], v3, s[64:67], s8 offen offset:512 sc1
    buffer_load_dwordx4 v[64:67], v3, s[64:67], s9 offen offset:512 sc1
    buffer_load_dwordx4 v[68:71], v3, s[64:67], s10 offen offset:512 sc1
    v_lshrrev_b32 v32, 2, v36
    v_add_u32 v32, v32, v33
    s_mul_i32 s76, s73, 448
    s_lshl_b32 s77, s74, 6
    s_add_u32 s76, s76, s77
    v_add_lshl_u32 v32, v32, s76, 1
    s_waitcnt lgkmcnt(0)
    v_sub_f32 v34, 1.0, v31
    v_cvt_pk_bf16_f32 v34, 0, v34
    buffer_load_dwordx4 v[72:75], v3, s[64:67], 0 offen offset:0 sc1
    buffer_load_dwordx4 v[76:79], v3, s[64:67], s4 offen offset:0 sc1
    buffer_load_dwordx4 v[80:83], v3, s[64:67], s5 offen offset:0 sc1
    buffer_load_dwordx4 v[84:87], v3, s[64:67], s6 offen offset:0 sc1
    buffer_load_dwordx4 v[88:91], v3, s[64:67], s7 offen offset:0 sc1
    buffer_load_dwordx4 v[92:95], v3, s[64:67], s8 offen offset:0 sc1
    buffer_load_dwordx4 v[96:99], v3, s[64:67], s9 offen offset:0 sc1
    buffer_load_dwordx4 v[100:103], v3, s[64:67], s10 offen offset:0 sc1
    s_waitcnt vmcnt(0)
L_poll_151:
    v_xor_b32 v28, s68, v41
    v_xor_b32 v29, s69, v43
    v_bitop3_b32 v28, v28, s68, v45 bitop3:0xf6
    v_bitop3_b32 v29, v29, s69, v47 bitop3:0xf6
    v_bitop3_b32 v28, v28, s68, v49 bitop3:0xf6
    v_bitop3_b32 v29, v29, s69, v51 bitop3:0xf6
    v_bitop3_b32 v28, v28, s68, v53 bitop3:0xf6
    v_bitop3_b32 v29, v29, s69, v55 bitop3:0xf6
    v_bitop3_b32 v28, v28, s68, v57 bitop3:0xf6
    v_bitop3_b32 v29, v29, s69, v59 bitop3:0xf6
    v_bitop3_b32 v28, v28, s68, v61 bitop3:0xf6
    v_bitop3_b32 v29, v29, s69, v63 bitop3:0xf6
    v_bitop3_b32 v28, v28, s68, v65 bitop3:0xf6
    v_bitop3_b32 v29, v29, s69, v67 bitop3:0xf6
    v_bitop3_b32 v28, v28, s68, v69 bitop3:0xf6
    v_bitop3_b32 v29, v29, s69, v71 bitop3:0xf6
    v_or_b32 v28, v28, v29
    v_cmp_ne_u32 vcc, 0, v28
    s_cbranch_vccz L_pdone_152
    s_cmp_eq_u32 s83, 0
    s_cbranch_scc1 L_pdone_152
    s_sub_u32 s83, s83, 1
    buffer_load_dwordx4 v[40:43], v3, s[64:67], 0 offen offset:512 sc1
    buffer_load_dwordx4 v[44:47], v3, s[64:67], s4 offen offset:512 sc1
    buffer_load_dwordx4 v[48:51], v3, s[64:67], s5 offen offset:512 sc1
    buffer_load_dwordx4 v[52:55], v3, s[64:67], s6 offen offset:512 sc1
    buffer_load_dwordx4 v[56:59], v3, s[64:67], s7 offen offset:512 sc1
    buffer_load_dwordx4 v[60:63], v3, s[64:67], s8 offen offset:512 sc1
    buffer_load_dwordx4 v[64:67], v3, s[64:67], s9 offen offset:512 sc1
    buffer_load_dwordx4 v[68:71], v3, s[64:67], s10 offen offset:512 sc1
    s_waitcnt vmcnt(0)
    s_branch L_poll_151
L_pdone_152:
    buffer_load_dwordx4 v[72:75], v3, s[64:67], 0 offen offset:0 sc1
    buffer_load_dwordx4 v[76:79], v3, s[64:67], s4 offen offset:0 sc1
    buffer_load_dwordx4 v[80:83], v3, s[64:67], s5 offen offset:0 sc1
    buffer_load_dwordx4 v[84:87], v3, s[64:67], s6 offen offset:0 sc1
    buffer_load_dwordx4 v[88:91], v3, s[64:67], s7 offen offset:0 sc1
    buffer_load_dwordx4 v[92:95], v3, s[64:67], s8 offen offset:0 sc1
    buffer_load_dwordx4 v[96:99], v3, s[64:67], s9 offen offset:0 sc1
    buffer_load_dwordx4 v[100:103], v3, s[64:67], s10 offen offset:0 sc1
    buffer_load_dwordx4 v[104:107], v3, s[64:67], 0 offen offset:0 sc1
    buffer_load_dwordx4 v[108:111], v3, s[64:67], s4 offen offset:0 sc1
    buffer_load_dwordx4 v[112:115], v3, s[64:67], s5 offen offset:0 sc1
    buffer_load_dwordx4 v[116:119], v3, s[64:67], s6 offen offset:0 sc1
    buffer_load_dwordx4 v[120:123], v3, s[64:67], s7 offen offset:0 sc1
    buffer_load_dwordx4 v[124:127], v3, s[64:67], s8 offen offset:0 sc1
    buffer_load_dwordx4 v[128:131], v3, s[64:67], s9 offen offset:0 sc1
    buffer_load_dwordx4 v[132:135], v3, s[64:67], s10 offen offset:0 sc1
    v_add_f32 v16, v40, v44
    v_add_f32 v17, v48, v52
    v_add_f32 v18, v56, v60
    v_add_f32 v19, v64, v68
    v_add_f32 v20, v42, v46
    v_add_f32 v21, v50, v54
    v_add_f32 v22, v58, v62
    v_add_f32 v23, v66, v70
    v_add_f32 v16, v16, v17
    v_add_f32 v18, v18, v19
    v_add_f32 v20, v20, v21
    v_add_f32 v22, v22, v23
    v_add_f32 v16, v16, v18
    v_add_f32 v20, v20, v22
    s_nop 1
    v_permlane32_swap_b32 v16, v20
    v_add_f32 v16, v16, v20
    v_cvt_pk_bf16_f32 v16, 0, v16
    v_mul_f32 v16, v34, v16
    v_cvt_pk_bf16_f32 v16, 0, v16
L_pp:
    buffer_load_dwordx4 v[136:139], v3, s[64:67], 0 offen offset:0 sc1
    buffer_load_dwordx4 v[140:143], v3, s[64:67], s4 offen offset:0 sc1
    buffer_load_dwordx4 v[144:147], v3, s[64:67], s5 offen offset:0 sc1
    buffer_load_dwordx4 v[148:151], v3, s[64:67], s6 offen offset:0 sc1
    buffer_load_dwordx4 v[152:155], v3, s[64:67], s7 offen offset:0 sc1
    buffer_load_dwordx4 v[156:159], v3, s[64:67], s8 offen offset:0 sc1
    buffer_load_dwordx4 v[160:163], v3, s[64:67], s9 offen offset:0 sc1
    buffer_load_dwordx4 v[164:167], v3, s[64:67], s10 offen offset:0 sc1
    s_waitcnt vmcnt(16)
    v_xor_b32 v28, s68, v73
    v_xor_b32 v29, s69, v75
    v_bitop3_b32 v28, v28, s68, v77 bitop3:0xf6
    v_bitop3_b32 v29, v29, s69, v79 bitop3:0xf6
    v_bitop3_b32 v28, v28, s68, v81 bitop3:0xf6
    v_bitop3_b32 v29, v29, s69, v83 bitop3:0xf6
    v_bitop3_b32 v28, v28, s68, v85 bitop3:0xf6
    v_bitop3_b32 v29, v29, s69, v87 bitop3:0xf6
    v_bitop3_b32 v28, v28, s68, v89 bitop3:0xf6
    v_bitop3_b32 v29, v29, s69, v91 bitop3:0xf6
    v_bitop3_b32 v28, v28, s68, v93 bitop3:0xf6
    v_bitop3_b32 v29, v29, s69, v95 bitop3:0xf6
    v_bitop3_b32 v28, v28, s68, v97 bitop3:0xf6
    v_bitop3_b32 v29, v29, s69, v99 bitop3:0xf6
    v_bitop3_b32 v28, v28, s68, v101 bitop3:0xf6
    v_bitop3_b32 v29, v29, s69, v103 bitop3:0xf6
    v_or_b32 v28, v28, v29
    v_cmp_ne_u32 vcc, 0, v28
    s_cbranch_vccz L_pph0
    buffer_load_dwordx4 v[72:75], v3, s[64:67], 0 offen offset:0 sc1
    buffer_load_dwordx4 v[76:79], v3, s[64:67], s4 offen offset:0 sc1
    buffer_load_dwordx4 v[80:83], v3, s[64:67], s5 offen offset:0 sc1
    buffer_load_dwordx4 v[84:87], v3, s[64:67], s6 offen offset:0 sc1
    buffer_load_dwordx4 v[88:91], v3, s[64:67], s7 offen offset:0 sc1
    buffer_load_dwordx4 v[92:95], v3, s[64:67], s8 offen offset:0 sc1
    buffer_load_dwordx4 v[96:99], v3, s[64:67], s9 offen offset:0 sc1
    buffer_load_dwordx4 v[100:103], v3, s[64:67], s10 offen offset:0 sc1
    s_waitcnt vmcnt(16)
    v_xor_b32 v28, s68, v105
    v_xor_b32 v29, s69, v107
    v_bitop3_b32 v28, v28, s68, v109 bitop3:0xf6
    v_bitop3_b32 v29, v29, s69, v111 bitop3:0xf6
    v_bitop3_b32 v28, v28, s68, v113 bitop3:0xf6
    v_bitop3_b32 v29, v29, s69, v115 bitop3:0xf6
    v_bitop3_b32 v28, v28, s68, v117 bitop3:0xf6
    v_bitop3_b32 v29, v29, s69, v119 bitop3:0xf6
    v_bitop3_b32 v28, v28, s68, v121 bitop3:0xf6
    v_bitop3_b32 v29, v29, s69, v123 bitop3:0xf6
    v_bitop3_b32 v28, v28, s68, v125 bitop3:0xf6
    v_bitop3_b32 v29, v29, s69, v127 bitop3:0xf6
    v_bitop3_b32 v28, v28, s68, v129 bitop3:0xf6
    v_bitop3_b32 v29, v29, s69, v131 bitop3:0xf6
    v_bitop3_b32 v28, v28, s68, v133 bitop3:0xf6
    v_bitop3_b32 v29, v29, s69, v135 bitop3:0xf6
    v_or_b32 v28, v28, v29
    v_cmp_ne_u32 vcc, 0, v28
    s_cbranch_vccz L_pph1
    buffer_load_dwordx4 v[104:107], v3, s[64:67], 0 offen offset:0 sc1
    buffer_load_dwordx4 v[108:111], v3, s[64:67], s4 offen offset:0 sc1
    buffer_load_dwordx4 v[112:115], v3, s[64:67], s5 offen offset:0 sc1
    buffer_load_dwordx4 v[116:119], v3, s[64:67], s6 offen offset:0 sc1
    buffer_load_dwordx4 v[120:123], v3, s[64:67], s7 offen offset:0 sc1
    buffer_load_dwordx4 v[124:127], v3, s[64:67], s8 offen offset:0 sc1
    buffer_load_dwordx4 v[128:131], v3, s[64:67], s9 offen offset:0 sc1
    buffer_load_dwordx4 v[132:135], v3, s[64:67], s10 offen offset:0 sc1
    s_waitcnt vmcnt(16)
    v_xor_b32 v28, s68, v137
    v_xor_b32 v29, s69, v139
    v_bitop3_b32 v28, v28, s68, v141 bitop3:0xf6
    v_bitop3_b32 v29, v29, s69, v143 bitop3:0xf6
    v_bitop3_b32 v28, v28, s68, v145 bitop3:0xf6
    v_bitop3_b32 v29, v29, s69, v147 bitop3:0xf6
    v_bitop3_b32 v28, v28, s68, v149 bitop3:0xf6
    v_bitop3_b32 v29, v29, s69, v151 bitop3:0xf6
    v_bitop3_b32 v28, v28, s68, v153 bitop3:0xf6
    v_bitop3_b32 v29, v29, s69, v155 bitop3:0xf6
    v_bitop3_b32 v28, v28, s68, v157 bitop3:0xf6
    v_bitop3_b32 v29, v29, s69, v159 bitop3:0xf6
    v_bitop3_b32 v28, v28, s68, v161 bitop3:0xf6
    v_bitop3_b32 v29, v29, s69, v163 bitop3:0xf6
    v_bitop3_b32 v28, v28, s68, v165 bitop3:0xf6
    v_bitop3_b32 v29, v29, s69, v167 bitop3:0xf6
    v_or_b32 v28, v28, v29
    v_cmp_ne_u32 vcc, 0, v28
    s_cbranch_vccz L_pph2
    s_cmp_eq_u32 s83, 0
    s_cbranch_scc1 L_pph0
    s_sub_u32 s83, s83, 1
    s_branch L_pp
L_pph2:
    v_add_f32 v8, v136, v140
    v_add_f32 v9, v144, v148
    v_add_f32 v10, v152, v156
    v_add_f32 v11, v160, v164
    v_add_f32 v12, v138, v142
    v_add_f32 v13, v146, v150
    v_add_f32 v14, v154, v158
    v_add_f32 v15, v162, v166
    v_add_f32 v8, v8, v9
    v_add_f32 v10, v10, v11
    v_add_f32 v12, v12, v13
    v_add_f32 v14, v14, v15
    v_add_f32 v8, v8, v10
    v_add_f32 v12, v12, v14
    s_nop 1
    v_permlane32_swap_b32 v8, v12
    v_add_f32 v8, v8, v12
    v_cvt_pk_bf16_f32 v8, 0, v8
    s_branch L_ppd
L_pph1:
    v_add_f32 v8, v104, v108
    v_add_f32 v9, v112, v116
    v_add_f32 v10, v120, v124
    v_add_f32 v11, v128, v132
    v_add_f32 v12, v106, v110
    v_add_f32 v13, v114, v118
    v_add_f32 v14, v122, v126
    v_add_f32 v15, v130, v134
    v_add_f32 v8, v8, v9
    v_add_f32 v10, v10, v11
    v_add_f32 v12, v12, v13
    v_add_f32 v14, v14, v15
    v_add_f32 v8, v8, v10
    v_add_f32 v12, v12, v14
    s_nop 1
    v_permlane32_swap_b32 v8, v12
    v_add_f32 v8, v8, v12
    v_cvt_pk_bf16_f32 v8, 0, v8
    s_branch L_ppd
L_pph0:
    v_add_f32 v8, v72, v76
    v_add_f32 v9, v80, v84
    v_add_f32 v10, v88, v92
    v_add_f32 v11, v96, v100
    v_add_f32 v12, v74, v78
    v_add_f32 v13, v82, v86
    v_add_f32 v14, v90, v94
    v_add_f32 v15, v98, v102
    v_add_f32 v8, v8, v9
    v_add_f32 v10, v10, v11
    v_add_f32 v12, v12, v13
    v_add_f32 v14, v14, v15
    v_add_f32 v8, v8, v10
    v_add_f32 v12, v12, v14
    s_nop 1
    v_permlane32_swap_b32 v8, v12
    v_add_f32 v8, v8, v12
    v_cvt_pk_bf16_f32 v8, 0, v8
L_ppd:
    v_mul_f32 v8, v31, v8
    v_cvt_pk_bf16_f32 v8, 0, v8
    v_add_f32 v8, v8, v16
    v_cvt_pk_bf16_f32 v8, v8, 0
    s_cbranch_execz L_fin
    buffer_store_short v8, v32, s[60:63], 0 offen
    s_cmp_lg_u32 s74, 0
    s_cbranch_scc1 L_fin
    s_lshl_b32 s76, s73, 7
    s_add_u32 s76, s76, 4194304
    v_mov_b32 v28, s76
    v_mov_b32 v38, s68
    v_mov_b32 v39, s69
    s_mov_b64 exec, 1
    buffer_store_dwordx2 v[38:39], v28, s[64:67], 0 offen
    s_mov_b64 exec, -1
L_fin:
L_end:
    s_endpgm

.fill 1024, 4, 0xbf810000

.section .rodata,"a"
.p2align 6
.amdhsa_kernel gated_mix__mha_block_cached__dense_activation_relu__decode_kernel
  .amdhsa_next_free_vgpr 168
  .amdhsa_next_free_sgpr 102
  .amdhsa_accum_offset 168
  .amdhsa_group_segment_fixed_size 0
  .amdhsa_kernarg_size 96
  .amdhsa_user_sgpr_count 2
  .amdhsa_user_sgpr_kernarg_segment_ptr 1
  .amdhsa_system_sgpr_workgroup_id_x 1
.end_amdhsa_kernel
```
